```python
import torch

def _softmax(x, axis=-1):
    return torch.softmax(x, dim=axis)
def _gelu(x):
    return torch.nn.functional.gelu(x, approximate="tanh")
def _silu(x):
    return torch.nn.functional.silu(x)
def _sigmoid(x):
    return torch.sigmoid(x)
def _layernorm(x, axis=-1, eps=1e-5):
    m = x.mean(dim=axis, keepdim=True)
    v = x.var(dim=axis, keepdim=True, unbiased=False)
    return (x - m) / torch.sqrt(v + eps)
def _scatter_add(tgt, idx, src, axis=0):
    return tgt.clone().index_add_(axis, idx, src)
def _segment_sum(src, seg, n):
    out = torch.zeros((n,) + src.shape[1:], dtype=src.dtype)
    return out.index_add_(0, seg, src)
def _pad(x, pw):
    flat = tuple(v for pair in reversed(pw) for v in pair)
    return torch.nn.functional.pad(x, flat)

kernel_name = 'gated_mix__sliding_block__sliding_local_dilated__prompt'

def setup_inputs():

    _w = (lambda a: (lambda t: t.to(torch.bfloat16) if t.is_floating_point() else t)(torch.as_tensor(a)))
    def _A_setup():
        B, S, D = 1, 2048, 448
        return {
            "x": _w((lambda *s: torch.randn(*s, dtype=torch.bfloat16) * 0.05)(B, S, D)),
            "wqkv": _w((lambda *s: torch.randn(*s, dtype=torch.bfloat16) * 1.6)(D, 3 * D)),
            "wo": _w((lambda *s: torch.randn(*s, dtype=torch.bfloat16) * 0.05)(D, D)),
        }
    _A_in = _A_setup()

    def _B_setup():
        B, S, D = 1, 2048, 448
        return {
            "x": _w((lambda *s: torch.randn(*s, dtype=torch.bfloat16) * 0.05)(B, S, D)),
            "wqkv": _w((lambda *s: torch.randn(*s, dtype=torch.bfloat16) * 1.6)(D, 3 * D)),
            "wo": _w((lambda *s: torch.randn(*s, dtype=torch.bfloat16) * 0.05)(D, D)),
        }
    _B_in = _B_setup()

    return {
        "A_x": _A_in["x"],
        "A_wqkv": _A_in["wqkv"],
        "A_wo": _A_in["wo"],
        "B_x": _B_in["x"],
        "B_wqkv": _B_in["wqkv"],
        "B_wo": _B_in["wo"],
        "gate_w": _w((lambda *s: torch.randn(*s, dtype=torch.bfloat16) * 0.05)(448) * 16.0),
    }

def reference(A_x, A_wqkv, A_wo, B_x, B_wqkv, B_wo, gate_w):
    def _A_ref(x, wqkv, wo):
        B, S, D = x.shape
        H = 16; Dh = D // H; W = 256
        qkv = (lambda x, *d: x.permute(*d))((x @ wqkv).reshape(B, S, 3, H, Dh), 2, 0, 3, 1, 4)
        q, k, v = qkv[0], qkv[1], qkv[2]
        scores = torch.einsum("bhqd,bhkd->bhqk", q, k) * (Dh ** -0.5)
        idx = torch.arange(S)
        mask = (idx[:, None] - idx[None, :] >= 0) & (idx[:, None] - idx[None, :] < W)
        scores = torch.where(mask[None, None], scores, -1e9)
        p = _softmax(scores, axis=-1)
        o = torch.einsum("bhqk,bhkd->bhqd", p, v)
        return (lambda x, *d: x.permute(*d))(o, 0, 2, 1, 3).reshape(B, S, D) @ wo

    def _B_ref(x, wqkv, wo):
        B, S, D = x.shape
        H = 16; Dh = D // H
        W, dil = 8, 2
        qkv = (lambda x, *d: x.permute(*d))((x @ wqkv).reshape(B, S, 3, H, Dh), 2, 0, 3, 1, 4)
        q, k, v = qkv[0], qkv[1], qkv[2]
        scale = Dh ** -0.5
        pos = torch.arange(S)
        off = torch.arange(W) * dil
        idx = pos[:, None] - off[None, :]
        mask = idx >= 0
        idx_c = torch.where(mask, idx, 0).reshape(-1)
        kg = k[:, :, idx_c, :].reshape(B, H, S, W, Dh)
        vg = v[:, :, idx_c, :].reshape(B, H, S, W, Dh)
        logits = torch.einsum("bhsd,bhswd->bhsw", q, kg) * scale
        logits = torch.where(mask[None, None, :, :], logits, -1e9)
        attn = _softmax(logits, axis=-1)
        o = torch.einsum("bhsw,bhswd->bhsd", attn, vg)
        return (lambda x, *d: x.permute(*d))(o, 0, 2, 1, 3).reshape(B, S, D) @ wo

    x = A_x
    g = _sigmoid((x * gate_w).sum(-1, keepdims=True))
    a = _A_ref(x, A_wqkv, A_wo)
    b = _B_ref(x, B_wqkv, B_wo)
    return g * a + (1 - g) * b
```

```asm
; @launch grid=(256,1,1) block=(512,1,1) lds=163840
.amdgcn_target "amdgcn-amd-amdhsa--gfx950"
.text
.globl gated_mix__sliding_block__sliding_local_dilated__prompt_kernel
.p2align 8
.type gated_mix__sliding_block__sliding_local_dilated__prompt_kernel,@function
gated_mix__sliding_block__sliding_local_dilated__prompt_kernel:
  s_cmp_ge_u32 s2, 256
  s_cbranch_scc1 L_end
  s_load_dwordx16 s[64:79], s[0:1], 0
  s_load_dwordx4 s[80:83], s[0:1], 64
  v_cmp_gt_u32 vcc, 8, v0
  s_and_saveexec_b64 s[44:45], vcc
  s_cbranch_execz L_cpf_1
  s_getpc_b64 s[46:47]
L_pc_here:
  s_lshr_b32 s38, s2, 3
  s_mul_i32 s38, s38, 1024
  v_lshlrev_b32 v39, 7, v0
  v_add_u32 v39, s38, v39
  v_min_u32 v39, L_end-L_pc_here, v39
  global_load_dword v63, v39, s[46:47]
L_cpf_1:
  s_mov_b64 exec, s[44:45]
  v_and_b32 v1, 63, v0
  v_lshrrev_b32 v2, 6, v0
  s_and_b32 s38, s2, 7
  s_lshr_b32 s39, s2, 3
  v_readfirstlane_b32 s34, v2
  s_and_b32 s40, s38, 1
  s_lshl_b32 s40, s40, 3
  s_and_b32 s41, s39, 7
  s_add_u32 s32, s40, s41
  s_lshr_b32 s40, s38, 1
  s_lshl_b32 s40, s40, 2
  s_lshr_b32 s41, s39, 3
  s_add_u32 s33, s40, s41
  s_lshl_b32 s48, s33, 4
  s_add_u32 s48, s48, s32
  s_and_b32 s35, s34, 3
  s_cmp_ge_u32 s34, 4
  s_cbranch_scc1 L_loader
  s_and_b32 s42, s32, 14
  s_lshr_b32 s39, s35, 1
  s_add_u32 s42, s42, s39
  s_and_b32 s50, s32, 1
  s_lshl_b32 s50, s50, 1
  s_and_b32 s39, s35, 1
  s_add_u32 s50, s50, s39
  s_mul_i32 s38, s42, 56
  s_mul_i32 s39, s33, 75264
  s_add_u32 s38, s38, s39
  s_sub_u32 s40, s50, 1
  s_max_i32 s40, s40, 0
  s_mul_i32 s40, s40, 896
  s_add_u32 s40, s40, s38
  s_lshl_b32 s43, s42, 2
  s_add_u32 s43, s43, s50
  s_mul_i32 s43, s43, 28672
  s_lshl_b32 s49, s42, 4
  s_add_u32 s49, s49, s33
  s_lshl_b32 s49, s49, 7
  s_lshl_b32 s39, s50, 15
  s_add_u32 s49, s49, s39
  s_add_u32 s49, s49, 0x30000
  s_mul_i32 s39, s33, 1792
  s_add_u32 s43, s43, s39
  s_add_u32 s43, s43, 0x100000
  v_lshrrev_b32 v6, 2, v1
  s_mov_b32 s39, 2688
  v_mul_lo_u32 v7, v6, s39
  v_and_b32 v8, 3, v1
  v_lshl_add_u32 v7, v8, 4, v7
  v_lshlrev_b32 v9, 4, v1
  v_lshlrev_b32 v10, 1, v6
  s_waitcnt lgkmcnt(0)
  s_cmp_eq_u32 s50, 0
  s_cselect_b32 s4, s66, s72
  s_cselect_b32 s5, s67, s73
  s_mov_b32 s6, 0x126000
  s_mov_b32 s7, 0x00020000
  buffer_load_dwordx4 v[16:19], v7, s[4:7], s40 offen
  s_add_u32 s40, s40, 43008
  s_mov_b32 exec_hi, 0xffff
  buffer_load_dwordx4 v[20:23], v7, s[4:7], s40 offen
  s_mov_b64 exec, -1
  s_mov_b32 s8, s76
  s_mov_b32 s9, s77
  s_mov_b32 s10, 0x380
  s_mov_b32 s11, 0x00020000
  s_mul_i32 s39, s33, 56
  buffer_load_ushort v32, v10, s[8:11], s39 offen
  buffer_load_ushort v33, v10, s[8:11], s39 offen offset:32
  s_mov_b32 s12, s82
  s_mov_b32 s13, s83
  s_mov_b32 s14, 0x10000000
  s_mov_b32 s15, 0x00020000
  s_mov_b32 s0, s82
  s_mov_b32 s1, s83
  v_mov_b32 v13, 0
  buffer_load_dword v14, v13, s[12:15], 0 offen sc1
  v_and_b32 v36, 31, v1
  v_lshrrev_b32 v37, 5, v1
  v_bfe_u32 v38, v1, 1, 3
  v_xor_b32 v38, v38, v37
  v_lshlrev_b32 v38, 4, v38
  v_lshl_add_u32 v38, v36, 7, v38
  s_lshl_b32 s38, s35, 12
  v_add_u32 v2, s38, v38
  v_xor_b32 v3, 32, v2
  v_xor_b32 v4, 64, v2
  v_xor_b32 v5, 96, v2
  v_lshlrev_b32 v11, 3, v37
  v_bfe_u32 v38, v1, 2, 2
  v_add_u32 v11, v11, v38
  v_lshlrev_b32 v11, 6, v11
  v_bfe_u32 v38, v1, 4, 1
  v_lshl_add_u32 v11, v38, 5, v11
  v_and_b32 v38, 3, v1
  v_lshl_add_u32 v11, v38, 3, v11
  v_lshlrev_b32 v36, 3, v37
  v_bfe_u32 v38, v1, 2, 2
  v_add_u32 v36, v36, v38
  v_lshlrev_b32 v36, 7, v36
  v_bfe_u32 v39, v1, 4, 1
  v_lshlrev_b32 v39, 2, v39
  v_and_b32 v37, 3, v1
  v_add_u32 v39, v39, v37
  v_lshrrev_b32 v38, 1, v38
  v_lshlrev_b32 v38, 3, v38
  v_xor_b32 v37, v39, v38
  v_lshl_add_u32 v251, v37, 3, v36
  v_add_u32 v39, 7, v39
  v_xor_b32 v37, v39, v38
  v_lshl_add_u32 v252, v37, 3, v36
  s_waitcnt vmcnt(0)
  v_readfirstlane_b32 s36, v14
  s_nop 3
  s_mul_i32 s36, s36, 0x9E3779B1
  s_add_u32 s36, s36, 0x7F4A7C15
  v_cmp_eq_u32 vcc, 3, v8
  v_and_b32 v34, 0xffff0000, v18
  v_or_b32 v34, v34, v32
  v_and_b32 v35, 0xffff0000, v22
  v_or_b32 v35, v35, v33
  s_cmp_eq_u32 s50, 0
  s_cselect_b64 s[38:39], vcc, 0
  v_cndmask_b32 v18, v18, v34, s[38:39]
  v_cndmask_b32 v22, v22, v35, s[38:39]
  buffer_store_dwordx4 v[16:19], v9, s[12:15], s43 offen sc1
  s_mov_b32 exec_hi, 0xffff
  buffer_store_dwordx4 v[20:23], v9, s[12:15], s43 offen offset:1024 sc1
  s_mov_b64 exec, -1
  v_mov_b32 v10, v11
  s_mov_b32 s16, s78
  s_mov_b32 s17, s79
  s_mov_b32 s18, 0x1c0000
  s_mov_b32 s19, 0x00020000
  s_mov_b32 s20, s74
  s_mov_b32 s21, s75
  s_mov_b32 s22, 0x62000
  s_mov_b32 s23, 0x00020000
  v_bfe_u32 v12, v1, 4, 1
  v_lshlrev_b32 v12, 10, v12
  v_lshrrev_b32 v13, 5, v1
  v_lshl_add_u32 v12, v13, 8, v12
  v_and_b32 v13, 15, v1
  v_lshl_add_u32 v12, v13, 4, v12
  s_lshl_b32 s38, s35, 11
  v_add_u32 v12, s38, v12
  v_mov_b32 v14, 0
  v_mov_b32 v15, 0x3f803f80
  v_cmp_lt_u32 s[82:83], 31, v1
  v_and_b32 v13, 31, v1
  v_cmp_eq_u32 s[66:67], 28, v13
  s_bitcmp1_b32 s32, 0
  s_cbranch_scc1 L_odd_2
  s_barrier
  v_add_u32 v11, 16384, v251
  v_add_u32 v253, 16384, v252
  v_add_u32 v6, 49152, v2
  v_add_u32 v7, 49152, v3
  v_add_u32 v8, 49152, v4
  v_add_u32 v9, 49152, v5
  ds_read_b128 v[80:83], v6
  ds_read_b64_tr_b16 v[192:193], v11 offset:0
  ds_read_b64_tr_b16 v[194:195], v11 offset:512
  ds_read_b64_tr_b16 v[196:197], v253 offset:0
  ds_read_b64_tr_b16 v[198:199], v253 offset:512
  ds_read_b128 v[84:87], v7
  ds_read_b64_tr_b16 v[200:201], v11 offset:2048
  ds_read_b64_tr_b16 v[202:203], v11 offset:2560
  ds_read_b64_tr_b16 v[204:205], v253 offset:2048
  ds_read_b64_tr_b16 v[206:207], v253 offset:2560
  s_waitcnt lgkmcnt(5)
  v_mfma_f32_32x32x16_bf16 v[16:31], v[192:195], v[80:83], 0
  ds_read_b128 v[88:91], v8
  ds_read_b64_tr_b16 v[208:209], v11 offset:4096
  v_mfma_f32_32x32x16_bf16 v[32:47], v[196:199], v[80:83], 0
  ds_read_b64_tr_b16 v[210:211], v11 offset:4608
  ds_read_b64_tr_b16 v[212:213], v253 offset:4096
  ds_read_b64_tr_b16 v[214:215], v253 offset:4608
  s_waitcnt lgkmcnt(5)
  v_mfma_f32_32x32x16_bf16 v[16:31], v[200:203], v[84:87], v[16:31]
  ds_read_b128 v[92:95], v9
  ds_read_b64_tr_b16 v[192:193], v11 offset:6144
  v_mfma_f32_32x32x16_bf16 v[32:47], v[204:207], v[84:87], v[32:47]
  ds_read_b64_tr_b16 v[194:195], v11 offset:6656
  ds_read_b64_tr_b16 v[196:197], v253 offset:6144
  ds_read_b64_tr_b16 v[198:199], v253 offset:6656
  s_waitcnt vmcnt(0)
  s_add_u32 s46, s0, s49
  s_addc_u32 s47, s1, 0
  s_mov_b32 s3, s36
  s_atomic_swap s3, s[46:47], 0
  v_lshlrev_b32 v248, 4, v1
  s_lshl_b32 s38, s34, 10
  s_add_u32 s39, s38, 122880
  v_add_u32 v240, s39, v248
  s_add_u32 s40, s34, 1
  s_lshr_b32 s41, s40, 1
  s_lshl_b32 s41, s41, 11
  s_and_b32 s40, s40, 1
  s_lshl_b32 s40, s40, 3
  s_add_u32 s40, s40, s41
  s_add_u32 s40, s40, 132096
  v_add_u32 v241, s40, v248
  s_add_u32 s40, s34, 2
  s_lshr_b32 s41, s40, 1
  s_lshl_b32 s41, s41, 11
  s_and_b32 s40, s40, 1
  s_lshl_b32 s40, s40, 3
  s_add_u32 s40, s40, s41
  s_add_u32 s40, s40, 132096
  v_add_u32 v242, s40, v248
  v_and_b32 v48, 15, v1
  s_lshl_b32 s39, s34, 6
  s_add_u32 s39, s39, 150528
  v_lshl_add_u32 v243, v48, 2, s39
  v_mov_b32 v249, 0xff800000
  v_lshrrev_b32 v49, 4, v1
  v_lshlrev_b32 v49, 2, v49
  s_and_b32 s38, s34, 1
  s_add_u32 s39, s34, s38
  s_cmp_eq_u32 s38, 0
  s_cselect_b32 s40, 16, 0
  s_add_u32 s40, s40, s34
  s_lshl_b32 s41, s39, 10
  v_add_u32 v244, s41, v248
  s_lshl_b32 s41, s40, 10
  v_add_u32 v245, s41, v248
  s_lshr_b32 s41, s39, 1
  s_lshl_b32 s41, s41, 11
  s_add_u32 s41, s41, 24576
  v_add_u32 v246, s41, v248
  s_lshr_b32 s41, s40, 1
  s_lshl_b32 s41, s41, 11
  s_and_b32 s42, s40, 1
  s_lshl_b32 s42, s42, 3
  s_add_u32 s41, s41, s42
  s_add_u32 s41, s41, 24576
  v_add_u32 v247, s41, v248
  v_add_u32 v50, 0, v49
  v_xor_b32 v51, v48, v50
  v_and_b32 v51, 1, v51
  v_cmp_eq_u32 s[40:41], 0, v51
  v_add_u32 v51, 2, v48
  v_cmp_ge_u32 s[24:25], v50, v51
  v_cmp_le_u32 s[42:43], v50, v48
  s_nop 1
  s_and_b64 s[24:25], s[24:25], s[40:41]
  s_and_b64 s[50:51], s[42:43], s[40:41]
  s_not_b64 s[44:45], s[42:43]
  s_cmp_eq_u32 s38, 0
  s_cselect_b64 s[84:85], s[44:45], -1
  s_cselect_b64 s[92:93], -1, s[42:43]
  s_cselect_b64 s[70:71], s[42:43], s[44:45]
  v_add_u32 v50, 1, v49
  v_xor_b32 v51, v48, v50
  v_and_b32 v51, 1, v51
  v_cmp_eq_u32 s[40:41], 0, v51
  v_add_u32 v51, 2, v48
  v_cmp_ge_u32 s[26:27], v50, v51
  v_cmp_le_u32 s[42:43], v50, v48
  s_nop 1
  s_and_b64 s[26:27], s[26:27], s[40:41]
  s_and_b64 s[52:53], s[42:43], s[40:41]
  s_not_b64 s[44:45], s[42:43]
  s_cmp_eq_u32 s38, 0
  s_cselect_b64 s[86:87], s[44:45], -1
  s_cselect_b64 s[94:95], -1, s[42:43]
  s_cselect_b64 s[72:73], s[42:43], s[44:45]
  v_add_u32 v50, 2, v49
  v_xor_b32 v51, v48, v50
  v_and_b32 v51, 1, v51
  v_cmp_eq_u32 s[40:41], 0, v51
  v_add_u32 v51, 2, v48
  v_cmp_ge_u32 s[28:29], v50, v51
  v_cmp_le_u32 s[42:43], v50, v48
  s_nop 1
  s_and_b64 s[28:29], s[28:29], s[40:41]
  s_and_b64 s[54:55], s[42:43], s[40:41]
  s_not_b64 s[44:45], s[42:43]
  s_cmp_eq_u32 s38, 0
  s_cselect_b64 s[88:89], s[44:45], -1
  s_cselect_b64 s[96:97], -1, s[42:43]
  s_cselect_b64 s[76:77], s[42:43], s[44:45]
  v_add_u32 v50, 3, v49
  v_xor_b32 v51, v48, v50
  v_and_b32 v51, 1, v51
  v_cmp_eq_u32 s[40:41], 0, v51
  v_add_u32 v51, 2, v48
  v_cmp_ge_u32 s[30:31], v50, v51
  v_cmp_le_u32 s[42:43], v50, v48
  s_nop 1
  s_and_b64 s[30:31], s[30:31], s[40:41]
  s_and_b64 s[56:57], s[42:43], s[40:41]
  s_not_b64 s[44:45], s[42:43]
  s_cmp_eq_u32 s38, 0
  s_cselect_b64 s[90:91], s[44:45], -1
  s_cselect_b64 s[98:99], -1, s[42:43]
  s_cselect_b64 s[78:79], s[42:43], s[44:45]
  s_or_b32 s40, s33, s34
  s_cmp_eq_u32 s40, 0
  s_cselect_b64 s[24:25], 0, s[24:25]
  s_cselect_b64 s[26:27], 0, s[26:27]
  s_cselect_b64 s[28:29], 0, s[28:29]
  s_cselect_b64 s[30:31], 0, s[30:31]
  s_cmp_ge_u32 s32, 7
  s_cselect_b32 s100, 1, 0
  s_mul_i32 s38, s100, 7
  s_sub_u32 s101, s32, s38
  v_lshrrev_b32 v50, 3, v1
  s_mov_b32 s38, 896
  v_mul_lo_u32 v50, v50, s38
  v_bfe_u32 v51, v1, 4, 1
  v_lshlrev_b32 v51, 2, v51
  v_and_b32 v52, 7, v1
  v_xor_b32 v51, v51, v52
  v_lshl_add_u32 v250, v51, 4, v50
  s_barrier
  v_add_u32 v11, 26624, v251
  v_add_u32 v253, 26624, v252
  v_add_u32 v6, 67584, v2
  v_add_u32 v7, 67584, v3
  v_add_u32 v8, 67584, v4
  v_add_u32 v9, 67584, v5
  s_waitcnt lgkmcnt(5)
  v_mfma_f32_32x32x16_bf16 v[16:31], v[208:211], v[88:91], v[16:31]
  ds_read_b128 v[96:99], v6
  ds_read_b64_tr_b16 v[200:201], v11 offset:0
  v_mfma_f32_32x32x16_bf16 v[32:47], v[212:215], v[88:91], v[32:47]
  ds_read_b64_tr_b16 v[202:203], v11 offset:512
  ds_read_b64_tr_b16 v[204:205], v253 offset:0
  ds_read_b64_tr_b16 v[206:207], v253 offset:512
  s_waitcnt lgkmcnt(5)
  v_mfma_f32_32x32x16_bf16 v[16:31], v[192:195], v[92:95], v[16:31]
  ds_read_b128 v[100:103], v7
  ds_read_b64_tr_b16 v[208:209], v11 offset:2048
  v_mfma_f32_32x32x16_bf16 v[32:47], v[196:199], v[92:95], v[32:47]
  ds_read_b64_tr_b16 v[210:211], v11 offset:2560
  ds_read_b64_tr_b16 v[212:213], v253 offset:2048
  ds_read_b64_tr_b16 v[214:215], v253 offset:2560
  s_waitcnt lgkmcnt(5)
  v_mfma_f32_32x32x16_bf16 v[16:31], v[200:203], v[96:99], v[16:31]
  ds_read_b128 v[104:107], v8
  ds_read_b64_tr_b16 v[192:193], v11 offset:4096
  v_mfma_f32_32x32x16_bf16 v[32:47], v[204:207], v[96:99], v[32:47]
  ds_read_b64_tr_b16 v[194:195], v11 offset:4608
  ds_read_b64_tr_b16 v[196:197], v253 offset:4096
  ds_read_b64_tr_b16 v[198:199], v253 offset:4608
  s_waitcnt lgkmcnt(5)
  v_mfma_f32_32x32x16_bf16 v[16:31], v[208:211], v[100:103], v[16:31]
  ds_read_b128 v[108:111], v9
  ds_read_b64_tr_b16 v[200:201], v11 offset:6144
  v_mfma_f32_32x32x16_bf16 v[32:47], v[212:215], v[100:103], v[32:47]
  ds_read_b64_tr_b16 v[202:203], v11 offset:6656
  ds_read_b64_tr_b16 v[204:205], v253 offset:6144
  ds_read_b64_tr_b16 v[206:207], v253 offset:6656
  s_barrier
  v_add_u32 v11, 34816, v251
  v_add_u32 v253, 34816, v252
  v_add_u32 v6, 86016, v2
  v_add_u32 v7, 86016, v3
  v_add_u32 v8, 86016, v4
  v_add_u32 v9, 86016, v5
  s_waitcnt lgkmcnt(5)
  v_mfma_f32_32x32x16_bf16 v[16:31], v[192:195], v[104:107], v[16:31]
  ds_read_b128 v[112:115], v6
  ds_read_b64_tr_b16 v[208:209], v11 offset:0
  v_mfma_f32_32x32x16_bf16 v[32:47], v[196:199], v[104:107], v[32:47]
  ds_read_b64_tr_b16 v[210:211], v11 offset:512
  ds_read_b64_tr_b16 v[212:213], v253 offset:0
  ds_read_b64_tr_b16 v[214:215], v253 offset:512
  s_waitcnt lgkmcnt(5)
  v_mfma_f32_32x32x16_bf16 v[16:31], v[200:203], v[108:111], v[16:31]
  ds_read_b128 v[116:119], v7
  ds_read_b64_tr_b16 v[192:193], v11 offset:2048
  v_mfma_f32_32x32x16_bf16 v[32:47], v[204:207], v[108:111], v[32:47]
  ds_read_b64_tr_b16 v[194:195], v11 offset:2560
  ds_read_b64_tr_b16 v[196:197], v253 offset:2048
  ds_read_b64_tr_b16 v[198:199], v253 offset:2560
  s_waitcnt lgkmcnt(5)
  v_mfma_f32_32x32x16_bf16 v[16:31], v[208:211], v[112:115], v[16:31]
  ds_read_b128 v[120:123], v8
  ds_read_b64_tr_b16 v[200:201], v11 offset:4096
  v_mfma_f32_32x32x16_bf16 v[32:47], v[212:215], v[112:115], v[32:47]
  ds_read_b64_tr_b16 v[202:203], v11 offset:4608
  ds_read_b64_tr_b16 v[204:205], v253 offset:4096
  ds_read_b64_tr_b16 v[206:207], v253 offset:4608
  s_waitcnt lgkmcnt(5)
  v_mfma_f32_32x32x16_bf16 v[16:31], v[192:195], v[116:119], v[16:31]
  ds_read_b128 v[124:127], v9
  ds_read_b64_tr_b16 v[208:209], v11 offset:6144
  v_mfma_f32_32x32x16_bf16 v[32:47], v[196:199], v[116:119], v[32:47]
  ds_read_b64_tr_b16 v[210:211], v11 offset:6656
  ds_read_b64_tr_b16 v[212:213], v253 offset:6144
  ds_read_b64_tr_b16 v[214:215], v253 offset:6656
  s_barrier
  v_add_u32 v11, 49152, v251
  v_add_u32 v253, 49152, v252
  v_add_u32 v6, 104448, v2
  v_add_u32 v7, 104448, v3
  v_add_u32 v8, 104448, v4
  v_add_u32 v9, 104448, v5
  s_waitcnt lgkmcnt(5)
  v_mfma_f32_32x32x16_bf16 v[16:31], v[200:203], v[120:123], v[16:31]
  ds_read_b128 v[128:131], v6
  ds_read_b64_tr_b16 v[192:193], v11 offset:0
  v_mfma_f32_32x32x16_bf16 v[32:47], v[204:207], v[120:123], v[32:47]
  ds_read_b64_tr_b16 v[194:195], v11 offset:512
  ds_read_b64_tr_b16 v[196:197], v253 offset:0
  ds_read_b64_tr_b16 v[198:199], v253 offset:512
  s_waitcnt lgkmcnt(5)
  v_mfma_f32_32x32x16_bf16 v[16:31], v[208:211], v[124:127], v[16:31]
  ds_read_b128 v[132:135], v7
  ds_read_b64_tr_b16 v[200:201], v11 offset:2048
  v_mfma_f32_32x32x16_bf16 v[32:47], v[212:215], v[124:127], v[32:47]
  ds_read_b64_tr_b16 v[202:203], v11 offset:2560
  ds_read_b64_tr_b16 v[204:205], v253 offset:2048
  ds_read_b64_tr_b16 v[206:207], v253 offset:2560
  s_waitcnt lgkmcnt(5)
  v_mfma_f32_32x32x16_bf16 v[16:31], v[192:195], v[128:131], v[16:31]
  ds_read_b128 v[136:139], v8
  ds_read_b64_tr_b16 v[208:209], v11 offset:4096
  v_mfma_f32_32x32x16_bf16 v[32:47], v[196:199], v[128:131], v[32:47]
  ds_read_b64_tr_b16 v[210:211], v11 offset:4608
  ds_read_b64_tr_b16 v[212:213], v253 offset:4096
  ds_read_b64_tr_b16 v[214:215], v253 offset:4608
  s_waitcnt lgkmcnt(5)
  v_mfma_f32_32x32x16_bf16 v[16:31], v[200:203], v[132:135], v[16:31]
  ds_read_b128 v[140:143], v9
  ds_read_b64_tr_b16 v[192:193], v11 offset:6144
  v_mfma_f32_32x32x16_bf16 v[32:47], v[204:207], v[132:135], v[32:47]
  ds_read_b64_tr_b16 v[194:195], v11 offset:6656
  ds_read_b64_tr_b16 v[196:197], v253 offset:6144
  ds_read_b64_tr_b16 v[198:199], v253 offset:6656
  s_barrier
  v_add_u32 v11, 57344, v251
  v_add_u32 v253, 57344, v252
  v_add_u32 v6, 122880, v2
  v_add_u32 v7, 122880, v3
  v_add_u32 v8, 122880, v4
  v_add_u32 v9, 122880, v5
  s_waitcnt lgkmcnt(5)
  v_mfma_f32_32x32x16_bf16 v[16:31], v[208:211], v[136:139], v[16:31]
  ds_read_b128 v[144:147], v6
  ds_read_b64_tr_b16 v[200:201], v11 offset:0
  v_mfma_f32_32x32x16_bf16 v[32:47], v[212:215], v[136:139], v[32:47]
  ds_read_b64_tr_b16 v[202:203], v11 offset:512
  ds_read_b64_tr_b16 v[204:205], v253 offset:0
  ds_read_b64_tr_b16 v[206:207], v253 offset:512
  s_waitcnt lgkmcnt(5)
  v_mfma_f32_32x32x16_bf16 v[16:31], v[192:195], v[140:143], v[16:31]
  ds_read_b128 v[148:151], v7
  ds_read_b64_tr_b16 v[208:209], v11 offset:2048
  v_mfma_f32_32x32x16_bf16 v[32:47], v[196:199], v[140:143], v[32:47]
  ds_read_b64_tr_b16 v[210:211], v11 offset:2560
  ds_read_b64_tr_b16 v[212:213], v253 offset:2048
  ds_read_b64_tr_b16 v[214:215], v253 offset:2560
  s_waitcnt lgkmcnt(5)
  v_mfma_f32_32x32x16_bf16 v[16:31], v[200:203], v[144:147], v[16:31]
  ds_read_b128 v[152:155], v8
  ds_read_b64_tr_b16 v[192:193], v11 offset:4096
  v_mfma_f32_32x32x16_bf16 v[32:47], v[204:207], v[144:147], v[32:47]
  ds_read_b64_tr_b16 v[194:195], v11 offset:4608
  ds_read_b64_tr_b16 v[196:197], v253 offset:4096
  ds_read_b64_tr_b16 v[198:199], v253 offset:4608
  s_waitcnt lgkmcnt(5)
  v_mfma_f32_32x32x16_bf16 v[16:31], v[208:211], v[148:151], v[16:31]
  ds_read_b128 v[156:159], v9
  ds_read_b64_tr_b16 v[200:201], v11 offset:6144
  v_mfma_f32_32x32x16_bf16 v[32:47], v[212:215], v[148:151], v[32:47]
  ds_read_b64_tr_b16 v[202:203], v11 offset:6656
  ds_read_b64_tr_b16 v[204:205], v253 offset:6144
  ds_read_b64_tr_b16 v[206:207], v253 offset:6656
  s_barrier
  v_add_u32 v11, 67584, v251
  v_add_u32 v253, 67584, v252
  v_add_u32 v6, 141312, v2
  v_add_u32 v7, 141312, v3
  v_add_u32 v8, 141312, v4
  v_add_u32 v9, 141312, v5
  s_waitcnt lgkmcnt(5)
  v_mfma_f32_32x32x16_bf16 v[16:31], v[192:195], v[152:155], v[16:31]
  ds_read_b128 v[160:163], v6
  ds_read_b64_tr_b16 v[208:209], v11 offset:0
  v_mfma_f32_32x32x16_bf16 v[32:47], v[196:199], v[152:155], v[32:47]
  ds_read_b64_tr_b16 v[210:211], v11 offset:512
  ds_read_b64_tr_b16 v[212:213], v253 offset:0
  ds_read_b64_tr_b16 v[214:215], v253 offset:512
  s_waitcnt lgkmcnt(5)
  v_mfma_f32_32x32x16_bf16 v[16:31], v[200:203], v[156:159], v[16:31]
  ds_read_b128 v[164:167], v7
  ds_read_b64_tr_b16 v[192:193], v11 offset:2048
  v_mfma_f32_32x32x16_bf16 v[32:47], v[204:207], v[156:159], v[32:47]
  ds_read_b64_tr_b16 v[194:195], v11 offset:2560
  ds_read_b64_tr_b16 v[196:197], v253 offset:2048
  ds_read_b64_tr_b16 v[198:199], v253 offset:2560
  s_waitcnt lgkmcnt(5)
  v_mfma_f32_32x32x16_bf16 v[16:31], v[208:211], v[160:163], v[16:31]
  ds_read_b128 v[168:171], v8
  ds_read_b64_tr_b16 v[200:201], v11 offset:4096
  v_mfma_f32_32x32x16_bf16 v[32:47], v[212:215], v[160:163], v[32:47]
  ds_read_b64_tr_b16 v[202:203], v11 offset:4608
  ds_read_b64_tr_b16 v[204:205], v253 offset:4096
  ds_read_b64_tr_b16 v[206:207], v253 offset:4608
  s_waitcnt lgkmcnt(5)
  v_mfma_f32_32x32x16_bf16 v[16:31], v[192:195], v[164:167], v[16:31]
  ds_read_b128 v[172:175], v9
  ds_read_b64_tr_b16 v[208:209], v11 offset:6144
  v_mfma_f32_32x32x16_bf16 v[32:47], v[196:199], v[164:167], v[32:47]
  ds_read_b64_tr_b16 v[210:211], v11 offset:6656
  ds_read_b64_tr_b16 v[212:213], v253 offset:6144
  ds_read_b64_tr_b16 v[214:215], v253 offset:6656
  s_barrier
  v_add_u32 v11, 75776, v251
  v_add_u32 v253, 75776, v252
  v_add_u32 v6, 0, v2
  v_add_u32 v7, 0, v3
  v_add_u32 v8, 0, v4
  v_add_u32 v9, 0, v5
  s_waitcnt lgkmcnt(5)
  v_mfma_f32_32x32x16_bf16 v[16:31], v[200:203], v[168:171], v[16:31]
  ds_read_b128 v[176:179], v6
  ds_read_b64_tr_b16 v[192:193], v11 offset:0
  v_mfma_f32_32x32x16_bf16 v[32:47], v[204:207], v[168:171], v[32:47]
  ds_read_b64_tr_b16 v[194:195], v11 offset:512
  ds_read_b64_tr_b16 v[196:197], v253 offset:0
  ds_read_b64_tr_b16 v[198:199], v253 offset:512
  s_waitcnt lgkmcnt(5)
  v_mfma_f32_32x32x16_bf16 v[16:31], v[208:211], v[172:175], v[16:31]
  ds_read_b128 v[180:183], v7
  ds_read_b64_tr_b16 v[200:201], v11 offset:2048
  v_mfma_f32_32x32x16_bf16 v[32:47], v[212:215], v[172:175], v[32:47]
  ds_read_b64_tr_b16 v[202:203], v11 offset:2560
  ds_read_b64_tr_b16 v[204:205], v253 offset:2048
  ds_read_b64_tr_b16 v[206:207], v253 offset:2560
  s_waitcnt lgkmcnt(5)
  v_mfma_f32_32x32x16_bf16 v[16:31], v[192:195], v[176:179], v[16:31]
  ds_read_b128 v[184:187], v8
  ds_read_b64_tr_b16 v[208:209], v11 offset:4096
  v_mfma_f32_32x32x16_bf16 v[32:47], v[196:199], v[176:179], v[32:47]
  ds_read_b64_tr_b16 v[210:211], v11 offset:4608
  ds_read_b64_tr_b16 v[212:213], v253 offset:4096
  ds_read_b64_tr_b16 v[214:215], v253 offset:4608
  s_waitcnt lgkmcnt(5)
  v_mfma_f32_32x32x16_bf16 v[16:31], v[200:203], v[180:183], v[16:31]
  ds_read_b128 v[188:191], v9
  ds_read_b64_tr_b16 v[192:193], v11 offset:6144
  v_mfma_f32_32x32x16_bf16 v[32:47], v[204:207], v[180:183], v[32:47]
  ds_read_b64_tr_b16 v[194:195], v11 offset:6656
  ds_read_b64_tr_b16 v[196:197], v253 offset:6144
  ds_read_b64_tr_b16 v[198:199], v253 offset:6656
  s_barrier
  v_add_u32 v11, 86016, v10
  s_waitcnt lgkmcnt(5)
  v_mfma_f32_32x32x16_bf16 v[16:31], v[208:211], v[184:187], v[16:31]
  ds_read_b64_tr_b16 v[200:201], v11 offset:0
  ds_read_b64_tr_b16 v[202:203], v11 offset:256
  v_mfma_f32_32x32x16_bf16 v[32:47], v[212:215], v[184:187], v[32:47]
  ds_read_b64_tr_b16 v[204:205], v11 offset:4096
  ds_read_b64_tr_b16 v[206:207], v11 offset:4352
  s_waitcnt lgkmcnt(4)
  v_mfma_f32_32x32x16_bf16 v[16:31], v[192:195], v[188:191], v[16:31]
  ds_read_b64_tr_b16 v[208:209], v11 offset:1024
  ds_read_b64_tr_b16 v[210:211], v11 offset:1280
  v_mfma_f32_32x32x16_bf16 v[32:47], v[196:199], v[188:191], v[32:47]
  ds_read_b64_tr_b16 v[212:213], v11 offset:5120
  ds_read_b64_tr_b16 v[214:215], v11 offset:5376
  s_lshl_b32 s38, s48, 14
  s_add_u32 s38, s38, 0x400000
  s_add_u32 s39, s38, 16384
  v_add_u32 v13, 16384, v12
  s_nop 7
  v_cvt_pk_bf16_f32 v2, v16, v17
  v_cvt_pk_bf16_f32 v3, v18, v19
  v_cvt_pk_bf16_f32 v4, v20, v21
  v_cvt_pk_bf16_f32 v5, v22, v23
  v_cvt_pk_bf16_f32 v6, v24, v25
  v_cvt_pk_bf16_f32 v7, v26, v27
  v_cvt_pk_bf16_f32 v8, v28, v29
  v_cvt_pk_bf16_f32 v9, v30, v31
  v_cndmask_b32 v8, v8, v14, s[82:83]
  v_cndmask_b32 v9, v9, v14, s[82:83]
  buffer_store_dwordx4 v[2:5], v12, s[12:15], s38 offen sc1
  buffer_store_dwordx4 v[6:9], v12, s[12:15], s38 offen offset:512 sc1
  ds_write_b128 v13, v[2:5]
  ds_write_b128 v13, v[6:9] offset:512
  v_cvt_pk_bf16_f32 v16, v32, v33
  v_cvt_pk_bf16_f32 v17, v34, v35
  v_cvt_pk_bf16_f32 v18, v36, v37
  v_cvt_pk_bf16_f32 v19, v38, v39
  v_cvt_pk_bf16_f32 v20, v40, v41
  v_cvt_pk_bf16_f32 v21, v42, v43
  v_cvt_pk_bf16_f32 v22, v44, v45
  v_cvt_pk_bf16_f32 v23, v46, v47
  v_cndmask_b32 v22, v22, v14, s[82:83]
  v_cndmask_b32 v23, v23, v14, s[82:83]
  buffer_store_dwordx4 v[16:19], v12, s[12:15], s39 offen sc1
  buffer_store_dwordx4 v[20:23], v12, s[12:15], s39 offen offset:512 sc1
  s_waitcnt lgkmcnt(0)
  s_branch L_jn_3
L_odd_2:
  s_barrier
  v_add_u32 v11, 16384, v251
  v_add_u32 v253, 16384, v252
  v_add_u32 v6, 49152, v2
  v_add_u32 v7, 49152, v3
  v_add_u32 v8, 49152, v4
  v_add_u32 v9, 49152, v5
  ds_read_b128 v[80:83], v6
  ds_read_b64_tr_b16 v[192:193], v11 offset:0
  ds_read_b64_tr_b16 v[194:195], v11 offset:512
  ds_read_b64_tr_b16 v[196:197], v253 offset:0
  ds_read_b64_tr_b16 v[198:199], v253 offset:512
  ds_read_b128 v[84:87], v7
  ds_read_b64_tr_b16 v[200:201], v11 offset:2048
  ds_read_b64_tr_b16 v[202:203], v11 offset:2560
  ds_read_b64_tr_b16 v[204:205], v253 offset:2048
  ds_read_b64_tr_b16 v[206:207], v253 offset:2560
  s_waitcnt lgkmcnt(5)
  v_mfma_f32_32x32x16_bf16 v[16:31], v[80:83], v[192:195], 0
  ds_read_b128 v[88:91], v8
  ds_read_b64_tr_b16 v[208:209], v11 offset:4096
  v_mfma_f32_32x32x16_bf16 v[32:47], v[80:83], v[196:199], 0
  ds_read_b64_tr_b16 v[210:211], v11 offset:4608
  ds_read_b64_tr_b16 v[212:213], v253 offset:4096
  ds_read_b64_tr_b16 v[214:215], v253 offset:4608
  s_waitcnt lgkmcnt(5)
  v_mfma_f32_32x32x16_bf16 v[16:31], v[84:87], v[200:203], v[16:31]
  ds_read_b128 v[92:95], v9
  ds_read_b64_tr_b16 v[192:193], v11 offset:6144
  v_mfma_f32_32x32x16_bf16 v[32:47], v[84:87], v[204:207], v[32:47]
  ds_read_b64_tr_b16 v[194:195], v11 offset:6656
  ds_read_b64_tr_b16 v[196:197], v253 offset:6144
  ds_read_b64_tr_b16 v[198:199], v253 offset:6656
  s_waitcnt vmcnt(0)
  s_add_u32 s46, s0, s49
  s_addc_u32 s47, s1, 0
  s_mov_b32 s3, s36
  s_atomic_swap s3, s[46:47], 0
  v_lshlrev_b32 v248, 4, v1
  s_lshl_b32 s38, s34, 10
  s_add_u32 s39, s38, 122880
  v_add_u32 v240, s39, v248
  s_add_u32 s40, s34, 1
  s_lshr_b32 s41, s40, 1
  s_lshl_b32 s41, s41, 11
  s_and_b32 s40, s40, 1
  s_lshl_b32 s40, s40, 3
  s_add_u32 s40, s40, s41
  s_add_u32 s40, s40, 132096
  v_add_u32 v241, s40, v248
  s_add_u32 s40, s34, 2
  s_lshr_b32 s41, s40, 1
  s_lshl_b32 s41, s41, 11
  s_and_b32 s40, s40, 1
  s_lshl_b32 s40, s40, 3
  s_add_u32 s40, s40, s41
  s_add_u32 s40, s40, 132096
  v_add_u32 v242, s40, v248
  v_and_b32 v48, 15, v1
  s_lshl_b32 s39, s34, 6
  s_add_u32 s39, s39, 150528
  v_lshl_add_u32 v243, v48, 2, s39
  v_mov_b32 v249, 0xff800000
  v_lshrrev_b32 v49, 4, v1
  v_lshlrev_b32 v49, 2, v49
  s_and_b32 s38, s34, 1
  s_add_u32 s39, s34, s38
  s_cmp_eq_u32 s38, 0
  s_cselect_b32 s40, 16, 0
  s_add_u32 s40, s40, s34
  s_lshl_b32 s41, s39, 10
  v_add_u32 v244, s41, v248
  s_lshl_b32 s41, s40, 10
  v_add_u32 v245, s41, v248
  s_lshr_b32 s41, s39, 1
  s_lshl_b32 s41, s41, 11
  s_add_u32 s41, s41, 24576
  v_add_u32 v246, s41, v248
  s_lshr_b32 s41, s40, 1
  s_lshl_b32 s41, s41, 11
  s_and_b32 s42, s40, 1
  s_lshl_b32 s42, s42, 3
  s_add_u32 s41, s41, s42
  s_add_u32 s41, s41, 24576
  v_add_u32 v247, s41, v248
  v_add_u32 v50, 0, v49
  v_xor_b32 v51, v48, v50
  v_and_b32 v51, 1, v51
  v_cmp_eq_u32 s[40:41], 0, v51
  v_add_u32 v51, 2, v48
  v_cmp_ge_u32 s[24:25], v50, v51
  v_cmp_le_u32 s[42:43], v50, v48
  s_nop 1
  s_and_b64 s[24:25], s[24:25], s[40:41]
  s_and_b64 s[50:51], s[42:43], s[40:41]
  s_not_b64 s[44:45], s[42:43]
  s_cmp_eq_u32 s38, 0
  s_cselect_b64 s[84:85], s[44:45], -1
  s_cselect_b64 s[92:93], -1, s[42:43]
  s_cselect_b64 s[70:71], s[42:43], s[44:45]
  v_add_u32 v50, 1, v49
  v_xor_b32 v51, v48, v50
  v_and_b32 v51, 1, v51
  v_cmp_eq_u32 s[40:41], 0, v51
  v_add_u32 v51, 2, v48
  v_cmp_ge_u32 s[26:27], v50, v51
  v_cmp_le_u32 s[42:43], v50, v48
  s_nop 1
  s_and_b64 s[26:27], s[26:27], s[40:41]
  s_and_b64 s[52:53], s[42:43], s[40:41]
  s_not_b64 s[44:45], s[42:43]
  s_cmp_eq_u32 s38, 0
  s_cselect_b64 s[86:87], s[44:45], -1
  s_cselect_b64 s[94:95], -1, s[42:43]
  s_cselect_b64 s[72:73], s[42:43], s[44:45]
  v_add_u32 v50, 2, v49
  v_xor_b32 v51, v48, v50
  v_and_b32 v51, 1, v51
  v_cmp_eq_u32 s[40:41], 0, v51
  v_add_u32 v51, 2, v48
  v_cmp_ge_u32 s[28:29], v50, v51
  v_cmp_le_u32 s[42:43], v50, v48
  s_nop 1
  s_and_b64 s[28:29], s[28:29], s[40:41]
  s_and_b64 s[54:55], s[42:43], s[40:41]
  s_not_b64 s[44:45], s[42:43]
  s_cmp_eq_u32 s38, 0
  s_cselect_b64 s[88:89], s[44:45], -1
  s_cselect_b64 s[96:97], -1, s[42:43]
  s_cselect_b64 s[76:77], s[42:43], s[44:45]
  v_add_u32 v50, 3, v49
  v_xor_b32 v51, v48, v50
  v_and_b32 v51, 1, v51
  v_cmp_eq_u32 s[40:41], 0, v51
  v_add_u32 v51, 2, v48
  v_cmp_ge_u32 s[30:31], v50, v51
  v_cmp_le_u32 s[42:43], v50, v48
  s_nop 1
  s_and_b64 s[30:31], s[30:31], s[40:41]
  s_and_b64 s[56:57], s[42:43], s[40:41]
  s_not_b64 s[44:45], s[42:43]
  s_cmp_eq_u32 s38, 0
  s_cselect_b64 s[90:91], s[44:45], -1
  s_cselect_b64 s[98:99], -1, s[42:43]
  s_cselect_b64 s[78:79], s[42:43], s[44:45]
  s_or_b32 s40, s33, s34
  s_cmp_eq_u32 s40, 0
  s_cselect_b64 s[24:25], 0, s[24:25]
  s_cselect_b64 s[26:27], 0, s[26:27]
  s_cselect_b64 s[28:29], 0, s[28:29]
  s_cselect_b64 s[30:31], 0, s[30:31]
  s_cmp_ge_u32 s32, 7
  s_cselect_b32 s100, 1, 0
  s_mul_i32 s38, s100, 7
  s_sub_u32 s101, s32, s38
  v_lshrrev_b32 v50, 3, v1
  s_mov_b32 s38, 896
  v_mul_lo_u32 v50, v50, s38
  v_bfe_u32 v51, v1, 4, 1
  v_lshlrev_b32 v51, 2, v51
  v_and_b32 v52, 7, v1
  v_xor_b32 v51, v51, v52
  v_lshl_add_u32 v250, v51, 4, v50
  s_barrier
  v_add_u32 v11, 26624, v251
  v_add_u32 v253, 26624, v252
  v_add_u32 v6, 67584, v2
  v_add_u32 v7, 67584, v3
  v_add_u32 v8, 67584, v4
  v_add_u32 v9, 67584, v5
  s_waitcnt lgkmcnt(5)
  v_mfma_f32_32x32x16_bf16 v[16:31], v[88:91], v[208:211], v[16:31]
  ds_read_b128 v[96:99], v6
  ds_read_b64_tr_b16 v[200:201], v11 offset:0
  v_mfma_f32_32x32x16_bf16 v[32:47], v[88:91], v[212:215], v[32:47]
  ds_read_b64_tr_b16 v[202:203], v11 offset:512
  ds_read_b64_tr_b16 v[204:205], v253 offset:0
  ds_read_b64_tr_b16 v[206:207], v253 offset:512
  s_waitcnt lgkmcnt(5)
  v_mfma_f32_32x32x16_bf16 v[16:31], v[92:95], v[192:195], v[16:31]
  ds_read_b128 v[100:103], v7
  ds_read_b64_tr_b16 v[208:209], v11 offset:2048
  v_mfma_f32_32x32x16_bf16 v[32:47], v[92:95], v[196:199], v[32:47]
  ds_read_b64_tr_b16 v[210:211], v11 offset:2560
  ds_read_b64_tr_b16 v[212:213], v253 offset:2048
  ds_read_b64_tr_b16 v[214:215], v253 offset:2560
  s_waitcnt lgkmcnt(5)
  v_mfma_f32_32x32x16_bf16 v[16:31], v[96:99], v[200:203], v[16:31]
  ds_read_b128 v[104:107], v8
  ds_read_b64_tr_b16 v[192:193], v11 offset:4096
  v_mfma_f32_32x32x16_bf16 v[32:47], v[96:99], v[204:207], v[32:47]
  ds_read_b64_tr_b16 v[194:195], v11 offset:4608
  ds_read_b64_tr_b16 v[196:197], v253 offset:4096
  ds_read_b64_tr_b16 v[198:199], v253 offset:4608
  s_waitcnt lgkmcnt(5)
  v_mfma_f32_32x32x16_bf16 v[16:31], v[100:103], v[208:211], v[16:31]
  ds_read_b128 v[108:111], v9
  ds_read_b64_tr_b16 v[200:201], v11 offset:6144
  v_mfma_f32_32x32x16_bf16 v[32:47], v[100:103], v[212:215], v[32:47]
  ds_read_b64_tr_b16 v[202:203], v11 offset:6656
  ds_read_b64_tr_b16 v[204:205], v253 offset:6144
  ds_read_b64_tr_b16 v[206:207], v253 offset:6656
  s_barrier
  v_add_u32 v11, 34816, v251
  v_add_u32 v253, 34816, v252
  v_add_u32 v6, 86016, v2
  v_add_u32 v7, 86016, v3
  v_add_u32 v8, 86016, v4
  v_add_u32 v9, 86016, v5
  s_waitcnt lgkmcnt(5)
  v_mfma_f32_32x32x16_bf16 v[16:31], v[104:107], v[192:195], v[16:31]
  ds_read_b128 v[112:115], v6
  ds_read_b64_tr_b16 v[208:209], v11 offset:0
  v_mfma_f32_32x32x16_bf16 v[32:47], v[104:107], v[196:199], v[32:47]
  ds_read_b64_tr_b16 v[210:211], v11 offset:512
  ds_read_b64_tr_b16 v[212:213], v253 offset:0
  ds_read_b64_tr_b16 v[214:215], v253 offset:512
  s_waitcnt lgkmcnt(5)
  v_mfma_f32_32x32x16_bf16 v[16:31], v[108:111], v[200:203], v[16:31]
  ds_read_b128 v[116:119], v7
  ds_read_b64_tr_b16 v[192:193], v11 offset:2048
  v_mfma_f32_32x32x16_bf16 v[32:47], v[108:111], v[204:207], v[32:47]
  ds_read_b64_tr_b16 v[194:195], v11 offset:2560
  ds_read_b64_tr_b16 v[196:197], v253 offset:2048
  ds_read_b64_tr_b16 v[198:199], v253 offset:2560
  s_waitcnt lgkmcnt(5)
  v_mfma_f32_32x32x16_bf16 v[16:31], v[112:115], v[208:211], v[16:31]
  ds_read_b128 v[120:123], v8
  ds_read_b64_tr_b16 v[200:201], v11 offset:4096
  v_mfma_f32_32x32x16_bf16 v[32:47], v[112:115], v[212:215], v[32:47]
  ds_read_b64_tr_b16 v[202:203], v11 offset:4608
  ds_read_b64_tr_b16 v[204:205], v253 offset:4096
  ds_read_b64_tr_b16 v[206:207], v253 offset:4608
  s_waitcnt lgkmcnt(5)
  v_mfma_f32_32x32x16_bf16 v[16:31], v[116:119], v[192:195], v[16:31]
  ds_read_b128 v[124:127], v9
  ds_read_b64_tr_b16 v[208:209], v11 offset:6144
  v_mfma_f32_32x32x16_bf16 v[32:47], v[116:119], v[196:199], v[32:47]
  ds_read_b64_tr_b16 v[210:211], v11 offset:6656
  ds_read_b64_tr_b16 v[212:213], v253 offset:6144
  ds_read_b64_tr_b16 v[214:215], v253 offset:6656
  s_barrier
  v_add_u32 v11, 49152, v251
  v_add_u32 v253, 49152, v252
  v_add_u32 v6, 104448, v2
  v_add_u32 v7, 104448, v3
  v_add_u32 v8, 104448, v4
  v_add_u32 v9, 104448, v5
  s_waitcnt lgkmcnt(5)
  v_mfma_f32_32x32x16_bf16 v[16:31], v[120:123], v[200:203], v[16:31]
  ds_read_b128 v[128:131], v6
  ds_read_b64_tr_b16 v[192:193], v11 offset:0
  v_mfma_f32_32x32x16_bf16 v[32:47], v[120:123], v[204:207], v[32:47]
  ds_read_b64_tr_b16 v[194:195], v11 offset:512
  ds_read_b64_tr_b16 v[196:197], v253 offset:0
  ds_read_b64_tr_b16 v[198:199], v253 offset:512
  s_waitcnt lgkmcnt(5)
  v_mfma_f32_32x32x16_bf16 v[16:31], v[124:127], v[208:211], v[16:31]
  ds_read_b128 v[132:135], v7
  ds_read_b64_tr_b16 v[200:201], v11 offset:2048
  v_mfma_f32_32x32x16_bf16 v[32:47], v[124:127], v[212:215], v[32:47]
  ds_read_b64_tr_b16 v[202:203], v11 offset:2560
  ds_read_b64_tr_b16 v[204:205], v253 offset:2048
  ds_read_b64_tr_b16 v[206:207], v253 offset:2560
  s_waitcnt lgkmcnt(5)
  v_mfma_f32_32x32x16_bf16 v[16:31], v[128:131], v[192:195], v[16:31]
  ds_read_b128 v[136:139], v8
  ds_read_b64_tr_b16 v[208:209], v11 offset:4096
  v_mfma_f32_32x32x16_bf16 v[32:47], v[128:131], v[196:199], v[32:47]
  ds_read_b64_tr_b16 v[210:211], v11 offset:4608
  ds_read_b64_tr_b16 v[212:213], v253 offset:4096
  ds_read_b64_tr_b16 v[214:215], v253 offset:4608
  s_waitcnt lgkmcnt(5)
  v_mfma_f32_32x32x16_bf16 v[16:31], v[132:135], v[200:203], v[16:31]
  ds_read_b128 v[140:143], v9
  ds_read_b64_tr_b16 v[192:193], v11 offset:6144
  v_mfma_f32_32x32x16_bf16 v[32:47], v[132:135], v[204:207], v[32:47]
  ds_read_b64_tr_b16 v[194:195], v11 offset:6656
  ds_read_b64_tr_b16 v[196:197], v253 offset:6144
  ds_read_b64_tr_b16 v[198:199], v253 offset:6656
  s_barrier
  v_add_u32 v11, 57344, v251
  v_add_u32 v253, 57344, v252
  v_add_u32 v6, 122880, v2
  v_add_u32 v7, 122880, v3
  v_add_u32 v8, 122880, v4
  v_add_u32 v9, 122880, v5
  s_waitcnt lgkmcnt(5)
  v_mfma_f32_32x32x16_bf16 v[16:31], v[136:139], v[208:211], v[16:31]
  ds_read_b128 v[144:147], v6
  ds_read_b64_tr_b16 v[200:201], v11 offset:0
  v_mfma_f32_32x32x16_bf16 v[32:47], v[136:139], v[212:215], v[32:47]
  ds_read_b64_tr_b16 v[202:203], v11 offset:512
  ds_read_b64_tr_b16 v[204:205], v253 offset:0
  ds_read_b64_tr_b16 v[206:207], v253 offset:512
  s_waitcnt lgkmcnt(5)
  v_mfma_f32_32x32x16_bf16 v[16:31], v[140:143], v[192:195], v[16:31]
  ds_read_b128 v[148:151], v7
  ds_read_b64_tr_b16 v[208:209], v11 offset:2048
  v_mfma_f32_32x32x16_bf16 v[32:47], v[140:143], v[196:199], v[32:47]
  ds_read_b64_tr_b16 v[210:211], v11 offset:2560
  ds_read_b64_tr_b16 v[212:213], v253 offset:2048
  ds_read_b64_tr_b16 v[214:215], v253 offset:2560
  s_waitcnt lgkmcnt(5)
  v_mfma_f32_32x32x16_bf16 v[16:31], v[144:147], v[200:203], v[16:31]
  ds_read_b128 v[152:155], v8
  ds_read_b64_tr_b16 v[192:193], v11 offset:4096
  v_mfma_f32_32x32x16_bf16 v[32:47], v[144:147], v[204:207], v[32:47]
  ds_read_b64_tr_b16 v[194:195], v11 offset:4608
  ds_read_b64_tr_b16 v[196:197], v253 offset:4096
  ds_read_b64_tr_b16 v[198:199], v253 offset:4608
  s_waitcnt lgkmcnt(5)
  v_mfma_f32_32x32x16_bf16 v[16:31], v[148:151], v[208:211], v[16:31]
  ds_read_b128 v[156:159], v9
  ds_read_b64_tr_b16 v[200:201], v11 offset:6144
  v_mfma_f32_32x32x16_bf16 v[32:47], v[148:151], v[212:215], v[32:47]
  ds_read_b64_tr_b16 v[202:203], v11 offset:6656
  ds_read_b64_tr_b16 v[204:205], v253 offset:6144
  ds_read_b64_tr_b16 v[206:207], v253 offset:6656
  s_barrier
  v_add_u32 v11, 67584, v251
  v_add_u32 v253, 67584, v252
  v_add_u32 v6, 141312, v2
  v_add_u32 v7, 141312, v3
  v_add_u32 v8, 141312, v4
  v_add_u32 v9, 141312, v5
  s_waitcnt lgkmcnt(5)
  v_mfma_f32_32x32x16_bf16 v[16:31], v[152:155], v[192:195], v[16:31]
  ds_read_b128 v[160:163], v6
  ds_read_b64_tr_b16 v[208:209], v11 offset:0
  v_mfma_f32_32x32x16_bf16 v[32:47], v[152:155], v[196:199], v[32:47]
  ds_read_b64_tr_b16 v[210:211], v11 offset:512
  ds_read_b64_tr_b16 v[212:213], v253 offset:0
  ds_read_b64_tr_b16 v[214:215], v253 offset:512
  s_waitcnt lgkmcnt(5)
  v_mfma_f32_32x32x16_bf16 v[16:31], v[156:159], v[200:203], v[16:31]
  ds_read_b128 v[164:167], v7
  ds_read_b64_tr_b16 v[192:193], v11 offset:2048
  v_mfma_f32_32x32x16_bf16 v[32:47], v[156:159], v[204:207], v[32:47]
  ds_read_b64_tr_b16 v[194:195], v11 offset:2560
  ds_read_b64_tr_b16 v[196:197], v253 offset:2048
  ds_read_b64_tr_b16 v[198:199], v253 offset:2560
  s_waitcnt lgkmcnt(5)
  v_mfma_f32_32x32x16_bf16 v[16:31], v[160:163], v[208:211], v[16:31]
  ds_read_b128 v[168:171], v8
  ds_read_b64_tr_b16 v[200:201], v11 offset:4096
  v_mfma_f32_32x32x16_bf16 v[32:47], v[160:163], v[212:215], v[32:47]
  ds_read_b64_tr_b16 v[202:203], v11 offset:4608
  ds_read_b64_tr_b16 v[204:205], v253 offset:4096
  ds_read_b64_tr_b16 v[206:207], v253 offset:4608
  s_waitcnt lgkmcnt(5)
  v_mfma_f32_32x32x16_bf16 v[16:31], v[164:167], v[192:195], v[16:31]
  ds_read_b128 v[172:175], v9
  ds_read_b64_tr_b16 v[208:209], v11 offset:6144
  v_mfma_f32_32x32x16_bf16 v[32:47], v[164:167], v[196:199], v[32:47]
  ds_read_b64_tr_b16 v[210:211], v11 offset:6656
  ds_read_b64_tr_b16 v[212:213], v253 offset:6144
  ds_read_b64_tr_b16 v[214:215], v253 offset:6656
  s_barrier
  v_add_u32 v11, 75776, v251
  v_add_u32 v253, 75776, v252
  v_add_u32 v6, 0, v2
  v_add_u32 v7, 0, v3
  v_add_u32 v8, 0, v4
  v_add_u32 v9, 0, v5
  s_waitcnt lgkmcnt(5)
  v_mfma_f32_32x32x16_bf16 v[16:31], v[168:171], v[200:203], v[16:31]
  ds_read_b128 v[176:179], v6
  ds_read_b64_tr_b16 v[192:193], v11 offset:0
  v_mfma_f32_32x32x16_bf16 v[32:47], v[168:171], v[204:207], v[32:47]
  ds_read_b64_tr_b16 v[194:195], v11 offset:512
  ds_read_b64_tr_b16 v[196:197], v253 offset:0
  ds_read_b64_tr_b16 v[198:199], v253 offset:512
  s_waitcnt lgkmcnt(5)
  v_mfma_f32_32x32x16_bf16 v[16:31], v[172:175], v[208:211], v[16:31]
  ds_read_b128 v[180:183], v7
  ds_read_b64_tr_b16 v[200:201], v11 offset:2048
  v_mfma_f32_32x32x16_bf16 v[32:47], v[172:175], v[212:215], v[32:47]
  ds_read_b64_tr_b16 v[202:203], v11 offset:2560
  ds_read_b64_tr_b16 v[204:205], v253 offset:2048
  ds_read_b64_tr_b16 v[206:207], v253 offset:2560
  s_waitcnt lgkmcnt(5)
  v_mfma_f32_32x32x16_bf16 v[16:31], v[176:179], v[192:195], v[16:31]
  ds_read_b128 v[184:187], v8
  ds_read_b64_tr_b16 v[208:209], v11 offset:4096
  v_mfma_f32_32x32x16_bf16 v[32:47], v[176:179], v[196:199], v[32:47]
  ds_read_b64_tr_b16 v[210:211], v11 offset:4608
  ds_read_b64_tr_b16 v[212:213], v253 offset:4096
  ds_read_b64_tr_b16 v[214:215], v253 offset:4608
  s_waitcnt lgkmcnt(5)
  v_mfma_f32_32x32x16_bf16 v[16:31], v[180:183], v[200:203], v[16:31]
  ds_read_b128 v[188:191], v9
  ds_read_b64_tr_b16 v[192:193], v11 offset:6144
  v_mfma_f32_32x32x16_bf16 v[32:47], v[180:183], v[204:207], v[32:47]
  ds_read_b64_tr_b16 v[194:195], v11 offset:6656
  ds_read_b64_tr_b16 v[196:197], v253 offset:6144
  ds_read_b64_tr_b16 v[198:199], v253 offset:6656
  s_barrier
  v_add_u32 v11, 86016, v10
  s_waitcnt lgkmcnt(5)
  v_mfma_f32_32x32x16_bf16 v[16:31], v[184:187], v[208:211], v[16:31]
  ds_read_b64_tr_b16 v[200:201], v11 offset:0
  ds_read_b64_tr_b16 v[202:203], v11 offset:256
  v_mfma_f32_32x32x16_bf16 v[32:47], v[184:187], v[212:215], v[32:47]
  ds_read_b64_tr_b16 v[204:205], v11 offset:4096
  ds_read_b64_tr_b16 v[206:207], v11 offset:4352
  s_waitcnt lgkmcnt(4)
  v_mfma_f32_32x32x16_bf16 v[16:31], v[188:191], v[192:195], v[16:31]
  ds_read_b64_tr_b16 v[208:209], v11 offset:1024
  ds_read_b64_tr_b16 v[210:211], v11 offset:1280
  v_mfma_f32_32x32x16_bf16 v[32:47], v[188:191], v[196:199], v[32:47]
  ds_read_b64_tr_b16 v[212:213], v11 offset:5120
  ds_read_b64_tr_b16 v[214:215], v11 offset:5376
  s_lshl_b32 s38, s48, 14
  s_add_u32 s38, s38, 0x400000
  s_add_u32 s39, s38, 8192
  s_sub_u32 s38, s38, 8192
  v_add_u32 v13, 40960, v12
  s_nop 7
  v_cvt_pk_bf16_f32 v2, v16, v17
  v_cvt_pk_bf16_f32 v3, v18, v19
  v_cvt_pk_bf16_f32 v4, v24, v25
  v_cvt_pk_bf16_f32 v5, v26, v27
  v_cvt_pk_bf16_f32 v6, v20, v21
  v_cvt_pk_bf16_f32 v7, v22, v23
  v_cvt_pk_bf16_f32 v8, v28, v29
  v_cvt_pk_bf16_f32 v9, v30, v31
  v_cndmask_b32 v2, v2, v15, s[66:67]
  v_cndmask_b32 v3, v3, v15, s[66:67]
  v_cndmask_b32 v4, v4, v15, s[66:67]
  v_cndmask_b32 v5, v5, v15, s[66:67]
  v_cndmask_b32 v6, v6, v15, s[66:67]
  v_cndmask_b32 v7, v7, v15, s[66:67]
  v_cndmask_b32 v8, v8, v15, s[66:67]
  v_cndmask_b32 v9, v9, v15, s[66:67]
  buffer_store_dwordx4 v[2:5], v12, s[12:15], s38 offen sc1
  buffer_store_dwordx4 v[6:9], v12, s[12:15], s38 offen offset:512 sc1
  v_cvt_pk_bf16_f32 v16, v32, v33
  v_cvt_pk_bf16_f32 v17, v34, v35
  v_cvt_pk_bf16_f32 v18, v40, v41
  v_cvt_pk_bf16_f32 v19, v42, v43
  v_cvt_pk_bf16_f32 v20, v36, v37
  v_cvt_pk_bf16_f32 v21, v38, v39
  v_cvt_pk_bf16_f32 v22, v44, v45
  v_cvt_pk_bf16_f32 v23, v46, v47
  v_cndmask_b32 v16, v16, v15, s[66:67]
  v_cndmask_b32 v17, v17, v15, s[66:67]
  v_cndmask_b32 v18, v18, v15, s[66:67]
  v_cndmask_b32 v19, v19, v15, s[66:67]
  v_cndmask_b32 v20, v20, v15, s[66:67]
  v_cndmask_b32 v21, v21, v15, s[66:67]
  v_cndmask_b32 v22, v22, v15, s[66:67]
  v_cndmask_b32 v23, v23, v15, s[66:67]
  buffer_store_dwordx4 v[16:19], v12, s[12:15], s39 offen sc1
  buffer_store_dwordx4 v[20:23], v12, s[12:15], s39 offen offset:512 sc1
  ds_write_b128 v13, v[16:19]
  ds_write_b128 v13, v[20:23] offset:512
  s_waitcnt lgkmcnt(0)
L_jn_3:
  s_waitcnt lgkmcnt(4)
  v_mfma_f32_32x32x16_bf16 v[48:63], v[200:203], v[80:83], 0
  ds_read_b64_tr_b16 v[192:193], v11 offset:2048
  ds_read_b64_tr_b16 v[194:195], v11 offset:2304
  v_mfma_f32_32x32x16_bf16 v[64:79], v[204:207], v[80:83], 0
  ds_read_b64_tr_b16 v[196:197], v11 offset:6144
  ds_read_b64_tr_b16 v[198:199], v11 offset:6400
  s_waitcnt lgkmcnt(4)
  v_mfma_f32_32x32x16_bf16 v[48:63], v[208:211], v[84:87], v[48:63]
  ds_read_b64_tr_b16 v[200:201], v11 offset:3072
  ds_read_b64_tr_b16 v[202:203], v11 offset:3328
  v_mfma_f32_32x32x16_bf16 v[64:79], v[212:215], v[84:87], v[64:79]
  ds_read_b64_tr_b16 v[204:205], v11 offset:7168
  ds_read_b64_tr_b16 v[206:207], v11 offset:7424
  s_barrier
  v_add_u32 v11, 94208, v10
  s_waitcnt lgkmcnt(4)
  v_mfma_f32_32x32x16_bf16 v[48:63], v[192:195], v[88:91], v[48:63]
  ds_read_b64_tr_b16 v[208:209], v11 offset:0
  ds_read_b64_tr_b16 v[210:211], v11 offset:256
  v_mfma_f32_32x32x16_bf16 v[64:79], v[196:199], v[88:91], v[64:79]
  ds_read_b64_tr_b16 v[212:213], v11 offset:4096
  ds_read_b64_tr_b16 v[214:215], v11 offset:4352
  s_waitcnt lgkmcnt(4)
  v_mfma_f32_32x32x16_bf16 v[48:63], v[200:203], v[92:95], v[48:63]
  ds_read_b64_tr_b16 v[192:193], v11 offset:1024
  ds_read_b64_tr_b16 v[194:195], v11 offset:1280
  v_mfma_f32_32x32x16_bf16 v[64:79], v[204:207], v[92:95], v[64:79]
  ds_read_b64_tr_b16 v[196:197], v11 offset:5120
  ds_read_b64_tr_b16 v[198:199], v11 offset:5376
  s_waitcnt lgkmcnt(4)
  v_mfma_f32_32x32x16_bf16 v[48:63], v[208:211], v[96:99], v[48:63]
  ds_read_b64_tr_b16 v[200:201], v11 offset:2048
  ds_read_b64_tr_b16 v[202:203], v11 offset:2304
  v_mfma_f32_32x32x16_bf16 v[64:79], v[212:215], v[96:99], v[64:79]
  ds_read_b64_tr_b16 v[204:205], v11 offset:6144
  ds_read_b64_tr_b16 v[206:207], v11 offset:6400
  s_waitcnt lgkmcnt(4)
  v_mfma_f32_32x32x16_bf16 v[48:63], v[192:195], v[100:103], v[48:63]
  ds_read_b64_tr_b16 v[208:209], v11 offset:3072
  ds_read_b64_tr_b16 v[210:211], v11 offset:3328
  v_mfma_f32_32x32x16_bf16 v[64:79], v[196:199], v[100:103], v[64:79]
  ds_read_b64_tr_b16 v[212:213], v11 offset:7168
  ds_read_b64_tr_b16 v[214:215], v11 offset:7424
  s_barrier
  v_add_u32 v11, 104448, v10
  s_waitcnt lgkmcnt(4)
  v_mfma_f32_32x32x16_bf16 v[48:63], v[200:203], v[104:107], v[48:63]
  ds_read_b64_tr_b16 v[192:193], v11 offset:0
  ds_read_b64_tr_b16 v[194:195], v11 offset:256
  v_mfma_f32_32x32x16_bf16 v[64:79], v[204:207], v[104:107], v[64:79]
  ds_read_b64_tr_b16 v[196:197], v11 offset:4096
  ds_read_b64_tr_b16 v[198:199], v11 offset:4352
  s_waitcnt lgkmcnt(4)
  v_mfma_f32_32x32x16_bf16 v[48:63], v[208:211], v[108:111], v[48:63]
  ds_read_b64_tr_b16 v[200:201], v11 offset:1024
  ds_read_b64_tr_b16 v[202:203], v11 offset:1280
  v_mfma_f32_32x32x16_bf16 v[64:79], v[212:215], v[108:111], v[64:79]
  ds_read_b64_tr_b16 v[204:205], v11 offset:5120
  ds_read_b64_tr_b16 v[206:207], v11 offset:5376
  s_waitcnt lgkmcnt(4)
  v_mfma_f32_32x32x16_bf16 v[48:63], v[192:195], v[112:115], v[48:63]
  ds_read_b64_tr_b16 v[208:209], v11 offset:2048
  ds_read_b64_tr_b16 v[210:211], v11 offset:2304
  v_mfma_f32_32x32x16_bf16 v[64:79], v[196:199], v[112:115], v[64:79]
  ds_read_b64_tr_b16 v[212:213], v11 offset:6144
  ds_read_b64_tr_b16 v[214:215], v11 offset:6400
  s_waitcnt lgkmcnt(4)
  v_mfma_f32_32x32x16_bf16 v[48:63], v[200:203], v[116:119], v[48:63]
  ds_read_b64_tr_b16 v[192:193], v11 offset:3072
  ds_read_b64_tr_b16 v[194:195], v11 offset:3328
  v_mfma_f32_32x32x16_bf16 v[64:79], v[204:207], v[116:119], v[64:79]
  ds_read_b64_tr_b16 v[196:197], v11 offset:7168
  ds_read_b64_tr_b16 v[198:199], v11 offset:7424
  s_waitcnt vmcnt(0)
  s_barrier
  v_add_u32 v11, 112640, v10
  s_waitcnt lgkmcnt(4)
  v_mfma_f32_32x32x16_bf16 v[48:63], v[208:211], v[120:123], v[48:63]
  ds_read_b64_tr_b16 v[200:201], v11 offset:0
  ds_read_b64_tr_b16 v[202:203], v11 offset:256
  v_mfma_f32_32x32x16_bf16 v[64:79], v[212:215], v[120:123], v[64:79]
  ds_read_b64_tr_b16 v[204:205], v11 offset:4096
  ds_read_b64_tr_b16 v[206:207], v11 offset:4352
  s_waitcnt lgkmcnt(4)
  v_mfma_f32_32x32x16_bf16 v[48:63], v[192:195], v[124:127], v[48:63]
  ds_read_b64_tr_b16 v[208:209], v11 offset:1024
  ds_read_b64_tr_b16 v[210:211], v11 offset:1280
  v_mfma_f32_32x32x16_bf16 v[64:79], v[196:199], v[124:127], v[64:79]
  ds_read_b64_tr_b16 v[212:213], v11 offset:5120
  ds_read_b64_tr_b16 v[214:215], v11 offset:5376
  s_waitcnt lgkmcnt(4)
  v_mfma_f32_32x32x16_bf16 v[48:63], v[200:203], v[128:131], v[48:63]
  ds_read_b64_tr_b16 v[192:193], v11 offset:2048
  ds_read_b64_tr_b16 v[194:195], v11 offset:2304
  v_mfma_f32_32x32x16_bf16 v[64:79], v[204:207], v[128:131], v[64:79]
  ds_read_b64_tr_b16 v[196:197], v11 offset:6144
  ds_read_b64_tr_b16 v[198:199], v11 offset:6400
  s_waitcnt lgkmcnt(4)
  v_mfma_f32_32x32x16_bf16 v[48:63], v[208:211], v[132:135], v[48:63]
  ds_read_b64_tr_b16 v[200:201], v11 offset:3072
  ds_read_b64_tr_b16 v[202:203], v11 offset:3328
  v_mfma_f32_32x32x16_bf16 v[64:79], v[212:215], v[132:135], v[64:79]
  ds_read_b64_tr_b16 v[204:205], v11 offset:7168
  ds_read_b64_tr_b16 v[206:207], v11 offset:7424
  s_barrier
  v_add_u32 v11, 122880, v10
  s_waitcnt lgkmcnt(4)
  v_mfma_f32_32x32x16_bf16 v[48:63], v[192:195], v[136:139], v[48:63]
  ds_read_b64_tr_b16 v[208:209], v11 offset:0
  ds_read_b64_tr_b16 v[210:211], v11 offset:256
  v_mfma_f32_32x32x16_bf16 v[64:79], v[196:199], v[136:139], v[64:79]
  ds_read_b64_tr_b16 v[212:213], v11 offset:4096
  ds_read_b64_tr_b16 v[214:215], v11 offset:4352
  s_waitcnt lgkmcnt(4)
  v_mfma_f32_32x32x16_bf16 v[48:63], v[200:203], v[140:143], v[48:63]
  ds_read_b64_tr_b16 v[192:193], v11 offset:1024
  ds_read_b64_tr_b16 v[194:195], v11 offset:1280
  v_mfma_f32_32x32x16_bf16 v[64:79], v[204:207], v[140:143], v[64:79]
  ds_read_b64_tr_b16 v[196:197], v11 offset:5120
  ds_read_b64_tr_b16 v[198:199], v11 offset:5376
  s_waitcnt lgkmcnt(4)
  v_mfma_f32_32x32x16_bf16 v[48:63], v[208:211], v[144:147], v[48:63]
  ds_read_b64_tr_b16 v[200:201], v11 offset:2048
  ds_read_b64_tr_b16 v[202:203], v11 offset:2304
  v_mfma_f32_32x32x16_bf16 v[64:79], v[212:215], v[144:147], v[64:79]
  ds_read_b64_tr_b16 v[204:205], v11 offset:6144
  ds_read_b64_tr_b16 v[206:207], v11 offset:6400
  s_waitcnt lgkmcnt(4)
  v_mfma_f32_32x32x16_bf16 v[48:63], v[192:195], v[148:151], v[48:63]
  ds_read_b64_tr_b16 v[208:209], v11 offset:3072
  ds_read_b64_tr_b16 v[210:211], v11 offset:3328
  v_mfma_f32_32x32x16_bf16 v[64:79], v[196:199], v[148:151], v[64:79]
  ds_read_b64_tr_b16 v[212:213], v11 offset:7168
  ds_read_b64_tr_b16 v[214:215], v11 offset:7424
  s_barrier
  v_add_u32 v11, 131072, v10
  s_waitcnt lgkmcnt(4)
  v_mfma_f32_32x32x16_bf16 v[48:63], v[200:203], v[152:155], v[48:63]
  ds_read_b64_tr_b16 v[192:193], v11 offset:0
  ds_read_b64_tr_b16 v[194:195], v11 offset:256
  v_mfma_f32_32x32x16_bf16 v[64:79], v[204:207], v[152:155], v[64:79]
  ds_read_b64_tr_b16 v[196:197], v11 offset:4096
  ds_read_b64_tr_b16 v[198:199], v11 offset:4352
  s_waitcnt lgkmcnt(4)
  v_mfma_f32_32x32x16_bf16 v[48:63], v[208:211], v[156:159], v[48:63]
  ds_read_b64_tr_b16 v[200:201], v11 offset:1024
  ds_read_b64_tr_b16 v[202:203], v11 offset:1280
  v_mfma_f32_32x32x16_bf16 v[64:79], v[212:215], v[156:159], v[64:79]
  ds_read_b64_tr_b16 v[204:205], v11 offset:5120
  ds_read_b64_tr_b16 v[206:207], v11 offset:5376
  s_waitcnt lgkmcnt(4)
  v_mfma_f32_32x32x16_bf16 v[48:63], v[192:195], v[160:163], v[48:63]
  ds_read_b64_tr_b16 v[208:209], v11 offset:2048
  ds_read_b64_tr_b16 v[210:211], v11 offset:2304
  v_mfma_f32_32x32x16_bf16 v[64:79], v[196:199], v[160:163], v[64:79]
  ds_read_b64_tr_b16 v[212:213], v11 offset:6144
  ds_read_b64_tr_b16 v[214:215], v11 offset:6400
  s_waitcnt lgkmcnt(4)
  v_mfma_f32_32x32x16_bf16 v[48:63], v[200:203], v[164:167], v[48:63]
  ds_read_b64_tr_b16 v[192:193], v11 offset:3072
  ds_read_b64_tr_b16 v[194:195], v11 offset:3328
  v_mfma_f32_32x32x16_bf16 v[64:79], v[204:207], v[164:167], v[64:79]
  ds_read_b64_tr_b16 v[196:197], v11 offset:7168
  ds_read_b64_tr_b16 v[198:199], v11 offset:7424
  s_barrier
  v_add_u32 v11, 141312, v10
  s_waitcnt lgkmcnt(4)
  v_mfma_f32_32x32x16_bf16 v[48:63], v[208:211], v[168:171], v[48:63]
  ds_read_b64_tr_b16 v[200:201], v11 offset:0
  ds_read_b64_tr_b16 v[202:203], v11 offset:256
  v_mfma_f32_32x32x16_bf16 v[64:79], v[212:215], v[168:171], v[64:79]
  ds_read_b64_tr_b16 v[204:205], v11 offset:4096
  ds_read_b64_tr_b16 v[206:207], v11 offset:4352
  s_waitcnt lgkmcnt(4)
  v_mfma_f32_32x32x16_bf16 v[48:63], v[192:195], v[172:175], v[48:63]
  ds_read_b64_tr_b16 v[208:209], v11 offset:1024
  ds_read_b64_tr_b16 v[210:211], v11 offset:1280
  v_mfma_f32_32x32x16_bf16 v[64:79], v[196:199], v[172:175], v[64:79]
  ds_read_b64_tr_b16 v[212:213], v11 offset:5120
  ds_read_b64_tr_b16 v[214:215], v11 offset:5376
  s_waitcnt lgkmcnt(4)
  v_mfma_f32_32x32x16_bf16 v[48:63], v[200:203], v[176:179], v[48:63]
  ds_read_b64_tr_b16 v[192:193], v11 offset:2048
  ds_read_b64_tr_b16 v[194:195], v11 offset:2304
  v_mfma_f32_32x32x16_bf16 v[64:79], v[204:207], v[176:179], v[64:79]
  ds_read_b64_tr_b16 v[196:197], v11 offset:6144
  ds_read_b64_tr_b16 v[198:199], v11 offset:6400
  s_waitcnt lgkmcnt(4)
  v_mfma_f32_32x32x16_bf16 v[48:63], v[208:211], v[180:183], v[48:63]
  ds_read_b64_tr_b16 v[200:201], v11 offset:3072
  ds_read_b64_tr_b16 v[202:203], v11 offset:3328
  v_mfma_f32_32x32x16_bf16 v[64:79], v[212:215], v[180:183], v[64:79]
  ds_read_b64_tr_b16 v[204:205], v11 offset:7168
  ds_read_b64_tr_b16 v[206:207], v11 offset:7424
  s_barrier
  v_add_u32 v11, 49152, v10
  s_waitcnt lgkmcnt(4)
  v_mfma_f32_32x32x16_bf16 v[48:63], v[192:195], v[184:187], v[48:63]
  ds_read_b64_tr_b16 v[208:209], v11 offset:0
  ds_read_b64_tr_b16 v[210:211], v11 offset:256
  v_mfma_f32_32x32x16_bf16 v[64:79], v[196:199], v[184:187], v[64:79]
  ds_read_b64_tr_b16 v[212:213], v11 offset:4096
  ds_read_b64_tr_b16 v[214:215], v11 offset:4352
  s_waitcnt lgkmcnt(4)
  v_mfma_f32_32x32x16_bf16 v[48:63], v[200:203], v[188:191], v[48:63]
  ds_read_b64_tr_b16 v[192:193], v11 offset:1024
  ds_read_b64_tr_b16 v[194:195], v11 offset:1280
  v_mfma_f32_32x32x16_bf16 v[64:79], v[204:207], v[188:191], v[64:79]
  ds_read_b64_tr_b16 v[196:197], v11 offset:5120
  ds_read_b64_tr_b16 v[198:199], v11 offset:5376
  s_waitcnt lgkmcnt(4)
  v_mfma_f32_32x32x16_bf16 v[16:31], v[208:211], v[80:83], 0
  ds_read_b64_tr_b16 v[200:201], v11 offset:2048
  ds_read_b64_tr_b16 v[202:203], v11 offset:2304
  v_mfma_f32_32x32x16_bf16 v[32:47], v[80:83], v[212:215], 0
  ds_read_b64_tr_b16 v[204:205], v11 offset:6144
  ds_read_b64_tr_b16 v[206:207], v11 offset:6400
  s_waitcnt lgkmcnt(4)
  v_mfma_f32_32x32x16_bf16 v[16:31], v[192:195], v[84:87], v[16:31]
  ds_read_b64_tr_b16 v[208:209], v11 offset:3072
  ds_read_b64_tr_b16 v[210:211], v11 offset:3328
  v_mfma_f32_32x32x16_bf16 v[32:47], v[84:87], v[196:199], v[32:47]
  ds_read_b64_tr_b16 v[212:213], v11 offset:7168
  ds_read_b64_tr_b16 v[214:215], v11 offset:7424
  v_add_u32 v11, 57344, v10
  s_waitcnt lgkmcnt(4)
  v_mfma_f32_32x32x16_bf16 v[16:31], v[200:203], v[88:91], v[16:31]
  ds_read_b64_tr_b16 v[192:193], v11 offset:0
  ds_read_b64_tr_b16 v[194:195], v11 offset:256
  v_mfma_f32_32x32x16_bf16 v[32:47], v[88:91], v[204:207], v[32:47]
  ds_read_b64_tr_b16 v[196:197], v11 offset:4096
  ds_read_b64_tr_b16 v[198:199], v11 offset:4352
  s_waitcnt lgkmcnt(4)
  v_mfma_f32_32x32x16_bf16 v[16:31], v[208:211], v[92:95], v[16:31]
  ds_read_b64_tr_b16 v[200:201], v11 offset:1024
  ds_read_b64_tr_b16 v[202:203], v11 offset:1280
  v_mfma_f32_32x32x16_bf16 v[32:47], v[92:95], v[212:215], v[32:47]
  ds_read_b64_tr_b16 v[204:205], v11 offset:5120
  ds_read_b64_tr_b16 v[206:207], v11 offset:5376
  s_waitcnt lgkmcnt(4)
  v_mfma_f32_32x32x16_bf16 v[16:31], v[192:195], v[96:99], v[16:31]
  ds_read_b64_tr_b16 v[208:209], v11 offset:2048
  ds_read_b64_tr_b16 v[210:211], v11 offset:2304
  v_mfma_f32_32x32x16_bf16 v[32:47], v[96:99], v[196:199], v[32:47]
  ds_read_b64_tr_b16 v[212:213], v11 offset:6144
  ds_read_b64_tr_b16 v[214:215], v11 offset:6400
  s_waitcnt lgkmcnt(4)
  v_mfma_f32_32x32x16_bf16 v[16:31], v[200:203], v[100:103], v[16:31]
  ds_read_b64_tr_b16 v[192:193], v11 offset:3072
  ds_read_b64_tr_b16 v[194:195], v11 offset:3328
  v_mfma_f32_32x32x16_bf16 v[32:47], v[100:103], v[204:207], v[32:47]
  ds_read_b64_tr_b16 v[196:197], v11 offset:7168
  ds_read_b64_tr_b16 v[198:199], v11 offset:7424
  s_lshl_b32 s38, s33, 3
  s_add_u32 s38, s38, s34
  s_lshl_b32 s38, s38, 4
  s_add_u32 s38, s38, s32
  s_lshl_b32 s39, s38, 10
  s_add_u32 s60, s39, 0xa00000
  s_add_u32 s61, s39, 0x800000
  s_lshl_b32 s39, s48, 7
  s_add_u32 s49, s39, 0x20000
  s_add_u32 s59, s39, 0x28000
  s_mul_i32 s46, s34, 50176
  s_lshl_b32 s38, s101, 7
  s_add_u32 s46, s46, s38
  s_cmp_ge_u32 s32, 14
  s_cselect_b32 s46, 0x20000000, s46
  s_mul_i32 s47, s34, 7168
  s_mov_b32 s20, s74
  s_mov_b32 s21, s75
  v_add_u32 v11, 67584, v10
  s_waitcnt lgkmcnt(4)
  v_mfma_f32_32x32x16_bf16 v[16:31], v[208:211], v[104:107], v[16:31]
  ds_read_b64_tr_b16 v[200:201], v11 offset:0
  ds_read_b64_tr_b16 v[202:203], v11 offset:256
  v_mfma_f32_32x32x16_bf16 v[32:47], v[104:107], v[212:215], v[32:47]
  ds_read_b64_tr_b16 v[204:205], v11 offset:4096
  ds_read_b64_tr_b16 v[206:207], v11 offset:4352
  s_waitcnt lgkmcnt(4)
  v_mfma_f32_32x32x16_bf16 v[16:31], v[192:195], v[108:111], v[16:31]
  ds_read_b64_tr_b16 v[208:209], v11 offset:1024
  ds_read_b64_tr_b16 v[210:211], v11 offset:1280
  v_mfma_f32_32x32x16_bf16 v[32:47], v[108:111], v[196:199], v[32:47]
  ds_read_b64_tr_b16 v[212:213], v11 offset:5120
  ds_read_b64_tr_b16 v[214:215], v11 offset:5376
  s_waitcnt lgkmcnt(4)
  v_mfma_f32_32x32x16_bf16 v[16:31], v[200:203], v[112:115], v[16:31]
  ds_read_b64_tr_b16 v[192:193], v11 offset:2048
  ds_read_b64_tr_b16 v[194:195], v11 offset:2304
  v_mfma_f32_32x32x16_bf16 v[32:47], v[112:115], v[204:207], v[32:47]
  ds_read_b64_tr_b16 v[196:197], v11 offset:6144
  ds_read_b64_tr_b16 v[198:199], v11 offset:6400
  s_waitcnt lgkmcnt(4)
  v_mfma_f32_32x32x16_bf16 v[16:31], v[208:211], v[116:119], v[16:31]
  ds_read_b64_tr_b16 v[200:201], v11 offset:3072
  ds_read_b64_tr_b16 v[202:203], v11 offset:3328
  v_mfma_f32_32x32x16_bf16 v[32:47], v[116:119], v[212:215], v[32:47]
  ds_read_b64_tr_b16 v[204:205], v11 offset:7168
  ds_read_b64_tr_b16 v[206:207], v11 offset:7424
  v_add_u32 v11, 75776, v10
  s_waitcnt lgkmcnt(4)
  v_mfma_f32_32x32x16_bf16 v[16:31], v[192:195], v[120:123], v[16:31]
  ds_read_b64_tr_b16 v[208:209], v11 offset:0
  ds_read_b64_tr_b16 v[210:211], v11 offset:256
  v_mfma_f32_32x32x16_bf16 v[32:47], v[120:123], v[196:199], v[32:47]
  ds_read_b64_tr_b16 v[212:213], v11 offset:4096
  ds_read_b64_tr_b16 v[214:215], v11 offset:4352
  s_waitcnt lgkmcnt(4)
  v_mfma_f32_32x32x16_bf16 v[16:31], v[200:203], v[124:127], v[16:31]
  ds_read_b64_tr_b16 v[192:193], v11 offset:1024
  ds_read_b64_tr_b16 v[194:195], v11 offset:1280
  v_mfma_f32_32x32x16_bf16 v[32:47], v[124:127], v[204:207], v[32:47]
  ds_read_b64_tr_b16 v[196:197], v11 offset:5120
  ds_read_b64_tr_b16 v[198:199], v11 offset:5376
  s_waitcnt lgkmcnt(4)
  v_mfma_f32_32x32x16_bf16 v[16:31], v[208:211], v[128:131], v[16:31]
  ds_read_b64_tr_b16 v[200:201], v11 offset:2048
  ds_read_b64_tr_b16 v[202:203], v11 offset:2304
  v_mfma_f32_32x32x16_bf16 v[32:47], v[128:131], v[212:215], v[32:47]
  ds_read_b64_tr_b16 v[204:205], v11 offset:6144
  ds_read_b64_tr_b16 v[206:207], v11 offset:6400
  s_waitcnt lgkmcnt(4)
  v_mfma_f32_32x32x16_bf16 v[16:31], v[192:195], v[132:135], v[16:31]
  ds_read_b64_tr_b16 v[208:209], v11 offset:3072
  ds_read_b64_tr_b16 v[210:211], v11 offset:3328
  v_mfma_f32_32x32x16_bf16 v[32:47], v[132:135], v[196:199], v[32:47]
  ds_read_b64_tr_b16 v[212:213], v11 offset:7168
  ds_read_b64_tr_b16 v[214:215], v11 offset:7424
  v_add_u32 v11, 86016, v10
  s_waitcnt lgkmcnt(4)
  v_mfma_f32_32x32x16_bf16 v[16:31], v[200:203], v[136:139], v[16:31]
  ds_read_b64_tr_b16 v[192:193], v11 offset:0
  ds_read_b64_tr_b16 v[194:195], v11 offset:256
  v_mfma_f32_32x32x16_bf16 v[32:47], v[136:139], v[204:207], v[32:47]
  ds_read_b64_tr_b16 v[196:197], v11 offset:4096
  ds_read_b64_tr_b16 v[198:199], v11 offset:4352
  s_waitcnt lgkmcnt(4)
  v_mfma_f32_32x32x16_bf16 v[16:31], v[208:211], v[140:143], v[16:31]
  ds_read_b64_tr_b16 v[200:201], v11 offset:1024
  ds_read_b64_tr_b16 v[202:203], v11 offset:1280
  v_mfma_f32_32x32x16_bf16 v[32:47], v[140:143], v[212:215], v[32:47]
  ds_read_b64_tr_b16 v[204:205], v11 offset:5120
  ds_read_b64_tr_b16 v[206:207], v11 offset:5376
  s_waitcnt lgkmcnt(4)
  v_mfma_f32_32x32x16_bf16 v[16:31], v[192:195], v[144:147], v[16:31]
  ds_read_b64_tr_b16 v[208:209], v11 offset:2048
  ds_read_b64_tr_b16 v[210:211], v11 offset:2304
  v_mfma_f32_32x32x16_bf16 v[32:47], v[144:147], v[196:199], v[32:47]
  ds_read_b64_tr_b16 v[212:213], v11 offset:6144
  ds_read_b64_tr_b16 v[214:215], v11 offset:6400
  s_waitcnt lgkmcnt(4)
  v_mfma_f32_32x32x16_bf16 v[16:31], v[200:203], v[148:151], v[16:31]
  ds_read_b64_tr_b16 v[192:193], v11 offset:3072
  ds_read_b64_tr_b16 v[194:195], v11 offset:3328
  v_mfma_f32_32x32x16_bf16 v[32:47], v[148:151], v[204:207], v[32:47]
  ds_read_b64_tr_b16 v[196:197], v11 offset:7168
  ds_read_b64_tr_b16 v[198:199], v11 offset:7424
  v_add_u32 v11, 94208, v10
  s_waitcnt lgkmcnt(4)
  v_mfma_f32_32x32x16_bf16 v[16:31], v[208:211], v[152:155], v[16:31]
  ds_read_b64_tr_b16 v[200:201], v11 offset:0
  ds_read_b64_tr_b16 v[202:203], v11 offset:256
  v_mfma_f32_32x32x16_bf16 v[32:47], v[152:155], v[212:215], v[32:47]
  ds_read_b64_tr_b16 v[204:205], v11 offset:4096
  ds_read_b64_tr_b16 v[206:207], v11 offset:4352
  s_waitcnt lgkmcnt(4)
  v_mfma_f32_32x32x16_bf16 v[16:31], v[192:195], v[156:159], v[16:31]
  ds_read_b64_tr_b16 v[208:209], v11 offset:1024
  ds_read_b64_tr_b16 v[210:211], v11 offset:1280
  v_mfma_f32_32x32x16_bf16 v[32:47], v[156:159], v[196:199], v[32:47]
  ds_read_b64_tr_b16 v[212:213], v11 offset:5120
  ds_read_b64_tr_b16 v[214:215], v11 offset:5376
  s_waitcnt lgkmcnt(4)
  v_mfma_f32_32x32x16_bf16 v[16:31], v[200:203], v[160:163], v[16:31]
  ds_read_b64_tr_b16 v[192:193], v11 offset:2048
  ds_read_b64_tr_b16 v[194:195], v11 offset:2304
  v_mfma_f32_32x32x16_bf16 v[32:47], v[160:163], v[204:207], v[32:47]
  ds_read_b64_tr_b16 v[196:197], v11 offset:6144
  ds_read_b64_tr_b16 v[198:199], v11 offset:6400
  s_waitcnt lgkmcnt(4)
  v_mfma_f32_32x32x16_bf16 v[16:31], v[208:211], v[164:167], v[16:31]
  ds_read_b64_tr_b16 v[200:201], v11 offset:3072
  ds_read_b64_tr_b16 v[202:203], v11 offset:3328
  v_mfma_f32_32x32x16_bf16 v[32:47], v[164:167], v[212:215], v[32:47]
  ds_read_b64_tr_b16 v[204:205], v11 offset:7168
  ds_read_b64_tr_b16 v[206:207], v11 offset:7424
  v_add_u32 v11, 104448, v10
  s_waitcnt lgkmcnt(4)
  v_mfma_f32_32x32x16_bf16 v[16:31], v[192:195], v[168:171], v[16:31]
  ds_read_b64_tr_b16 v[208:209], v11 offset:0
  ds_read_b64_tr_b16 v[210:211], v11 offset:256
  v_mfma_f32_32x32x16_bf16 v[32:47], v[168:171], v[196:199], v[32:47]
  ds_read_b64_tr_b16 v[212:213], v11 offset:4096
  ds_read_b64_tr_b16 v[214:215], v11 offset:4352
  s_waitcnt lgkmcnt(4)
  v_mfma_f32_32x32x16_bf16 v[16:31], v[200:203], v[172:175], v[16:31]
  ds_read_b64_tr_b16 v[192:193], v11 offset:1024
  ds_read_b64_tr_b16 v[194:195], v11 offset:1280
  v_mfma_f32_32x32x16_bf16 v[32:47], v[172:175], v[204:207], v[32:47]
  ds_read_b64_tr_b16 v[196:197], v11 offset:5120
  ds_read_b64_tr_b16 v[198:199], v11 offset:5376
  s_waitcnt lgkmcnt(4)
  v_mfma_f32_32x32x16_bf16 v[16:31], v[208:211], v[176:179], v[16:31]
  ds_read_b64_tr_b16 v[200:201], v11 offset:2048
  ds_read_b64_tr_b16 v[202:203], v11 offset:2304
  v_mfma_f32_32x32x16_bf16 v[32:47], v[176:179], v[212:215], v[32:47]
  ds_read_b64_tr_b16 v[204:205], v11 offset:6144
  ds_read_b64_tr_b16 v[206:207], v11 offset:6400
  s_waitcnt lgkmcnt(4)
  v_mfma_f32_32x32x16_bf16 v[16:31], v[192:195], v[180:183], v[16:31]
  ds_read_b64_tr_b16 v[208:209], v11 offset:3072
  ds_read_b64_tr_b16 v[210:211], v11 offset:3328
  v_mfma_f32_32x32x16_bf16 v[32:47], v[180:183], v[196:199], v[32:47]
  ds_read_b64_tr_b16 v[212:213], v11 offset:7168
  ds_read_b64_tr_b16 v[214:215], v11 offset:7424
  s_waitcnt lgkmcnt(4)
  v_mfma_f32_32x32x16_bf16 v[16:31], v[200:203], v[184:187], v[16:31]
  v_mfma_f32_32x32x16_bf16 v[32:47], v[184:187], v[204:207], v[32:47]
  s_waitcnt lgkmcnt(0)
  v_mfma_f32_32x32x16_bf16 v[16:31], v[208:211], v[188:191], v[16:31]
  v_mfma_f32_32x32x16_bf16 v[32:47], v[188:191], v[212:215], v[32:47]
  v_and_b32 v13, 31, v1
  s_mov_b32 s44, 0x3e8b97f6
  s_mov_b32 s45, 0x3e8b97f6
  v_lshlrev_b32 v193, 2, v13
  s_lshl_b32 s38, s35, 7
  s_add_u32 s38, s38, 150528
  v_add_u32 v193, s38, v193
  v_add_u32 v194, 512, v193
  v_cndmask_b32 v193, v194, v193, s[82:83]
  s_nop 4
  v_cvt_pk_bf16_f32 v196, v16, v17
  v_cvt_pk_bf16_f32 v197, v18, v19
  v_cvt_pk_bf16_f32 v198, v20, v21
  v_cvt_pk_bf16_f32 v199, v22, v23
  v_cvt_pk_bf16_f32 v200, v24, v25
  v_cvt_pk_bf16_f32 v201, v26, v27
  v_cvt_pk_bf16_f32 v202, v28, v29
  v_cvt_pk_bf16_f32 v203, v30, v31
  v_cndmask_b32 v202, v202, v14, s[82:83]
  v_cndmask_b32 v203, v203, v14, s[82:83]
  v_add_u32 v2, 123904, v12
  ds_write_b128 v2, v[196:199]
  ds_write_b128 v2, v[200:203] offset:512
  v_mul_f32 v192, 0xbfb8aa3b, v60
  v_exp_f32 v192, v192
  v_cvt_pk_bf16_f32 v204, v32, v33
  v_cvt_pk_bf16_f32 v205, v34, v35
  v_cvt_pk_bf16_f32 v206, v40, v41
  v_cvt_pk_bf16_f32 v207, v42, v43
  v_cvt_pk_bf16_f32 v208, v36, v37
  v_cvt_pk_bf16_f32 v209, v38, v39
  v_cvt_pk_bf16_f32 v210, v44, v45
  v_cvt_pk_bf16_f32 v211, v46, v47
  v_cndmask_b32 v204, v204, v15, s[66:67]
  v_cndmask_b32 v205, v205, v15, s[66:67]
  v_cndmask_b32 v206, v206, v15, s[66:67]
  v_cndmask_b32 v207, v207, v15, s[66:67]
  v_cndmask_b32 v208, v208, v15, s[66:67]
  v_cndmask_b32 v209, v209, v15, s[66:67]
  v_cndmask_b32 v210, v210, v15, s[66:67]
  v_cndmask_b32 v211, v211, v15, s[66:67]
  v_add_u32 v3, 134144, v12
  ds_write_b128 v3, v[204:207]
  ds_write_b128 v3, v[208:211] offset:512
  v_add_f32 v192, 1.0, v192
  v_rcp_f32 v192, v192
  v_pk_mul_f32 v[48:49], v[48:49], s[44:45]
  v_pk_mul_f32 v[50:51], v[50:51], s[44:45]
  v_pk_mul_f32 v[52:53], v[52:53], s[44:45]
  v_pk_mul_f32 v[54:55], v[54:55], s[44:45]
  v_pk_mul_f32 v[56:57], v[56:57], s[44:45]
  v_pk_mul_f32 v[58:59], v[58:59], s[44:45]
  v_pk_mul_f32 v[60:61], v[60:61], s[44:45]
  v_pk_mul_f32 v[62:63], v[62:63], s[44:45]
  v_pk_mul_f32 v[64:65], v[64:65], s[44:45]
  v_pk_mul_f32 v[66:67], v[66:67], s[44:45]
  v_pk_mul_f32 v[68:69], v[68:69], s[44:45]
  v_pk_mul_f32 v[70:71], v[70:71], s[44:45]
  v_pk_mul_f32 v[72:73], v[72:73], s[44:45]
  v_pk_mul_f32 v[74:75], v[74:75], s[44:45]
  v_pk_mul_f32 v[76:77], v[76:77], s[44:45]
  v_pk_mul_f32 v[78:79], v[78:79], s[44:45]
  ds_write_b32 v193, v192
  v_mov_b32 v228, 0x00003f80
  v_cvt_pk_bf16_f32 v212, v48, v49
  v_cvt_pk_bf16_f32 v213, v50, v51
  v_cvt_pk_bf16_f32 v214, v52, v53
  v_cvt_pk_bf16_f32 v215, v54, v55
  v_cvt_pk_bf16_f32 v216, v56, v57
  v_cvt_pk_bf16_f32 v217, v58, v59
  v_cvt_pk_bf16_f32 v218, v60, v61
  v_cvt_pk_bf16_f32 v219, v62, v63
  v_cndmask_b32 v218, v218, v228, s[82:83]
  v_cndmask_b32 v219, v219, v14, s[82:83]
  v_add_u32 v4, 155648, v12
  ds_write_b128 v4, v[212:215]
  ds_write_b128 v4, v[216:219] offset:512
  v_cvt_pk_bf16_f32 v220, v64, v65
  v_cvt_pk_bf16_f32 v221, v66, v67
  v_cvt_pk_bf16_f32 v222, v68, v69
  v_cvt_pk_bf16_f32 v223, v70, v71
  v_cvt_pk_bf16_f32 v224, v72, v73
  v_cvt_pk_bf16_f32 v225, v74, v75
  v_cvt_pk_bf16_f32 v226, v76, v77
  v_cvt_pk_bf16_f32 v227, v78, v79
  v_cndmask_b32 v226, v226, v14, s[82:83]
  v_cndmask_b32 v227, v227, v14, s[82:83]
  v_add_u32 v5, 142336, v12
  ds_write_b128 v5, v[220:223]
  ds_write_b128 v5, v[224:227] offset:512
  s_waitcnt lgkmcnt(0)
  s_branch L_attn
L_loader:
  v_lshrrev_b32 v8, 3, v1
  s_mov_b32 s38, 896
  v_mul_lo_u32 v8, v8, s38
  v_and_b32 v9, 7, v1
  v_lshrrev_b32 v10, 4, v1
  v_xor_b32 v9, v9, v10
  v_lshl_add_u32 v2, v9, 4, v8
  v_xor_b32 v3, 64, v2
  v_add_u32 v3, 7168, v3
  v_add_u32 v4, 14336, v2
  v_add_u32 v5, 14336, v3
  s_lshl_b32 s39, s35, 1
  v_add_u32 v10, s39, v10
  v_and_b32 v10, 7, v10
  v_and_b32 v9, 7, v1
  v_xor_b32 v9, v9, v10
  v_lshl_add_u32 v7, v9, 4, v8
  v_lshrrev_b32 v8, 3, v1
  s_mov_b32 s38, 2688
  v_mul_lo_u32 v8, v8, s38
  v_bfe_u32 v9, v1, 4, 1
  v_lshlrev_b32 v9, 2, v9
  v_and_b32 v10, 7, v1
  v_xor_b32 v9, v9, v10
  v_lshl_add_u32 v6, v9, 4, v8
  s_lshl_b32 s38, s33, 7
  s_lshl_b32 s39, s35, 5
  s_add_u32 s39, s38, s39
  s_mul_i32 s8, s39, 896
  s_sub_u32 s38, s38, 16
  s_max_i32 s38, s38, 0
  s_lshl_b32 s39, s35, 2
  s_add_u32 s38, s38, s39
  s_mul_i32 s9, s38, 896
  s_lshl_b32 s10, s35, 12
  s_lshl_b32 s11, s35, 9
  s_mul_i32 s59, s35, 43008
  s_lshr_b32 s39, s32, 1
  s_mul_i32 s39, s39, 112
  s_add_u32 s59, s59, s39
  s_and_b32 s39, s32, 1
  s_mul_i32 s39, s39, 896
  s_add_u32 s59, s59, s39
  s_add_u32 s59, s59, 896
  s_lshl_b32 s60, s35, 11
  s_waitcnt lgkmcnt(0)
  s_mov_b32 s4, s64
  s_mov_b32 s5, s65
  s_mov_b32 s6, 0x1c0000
  s_mov_b32 s7, 0x00020000
  s_mov_b32 s16, s66
  s_mov_b32 s17, s67
  s_mov_b32 s18, 0x126000
  s_mov_b32 s19, 0x00020000
  s_lshl_b32 s38, s33, 1
  s_add_u32 s38, s38, s32
  s_mul_i32 s39, s38, 37
  s_lshr_b32 s39, s39, 8
  s_mul_i32 s39, s39, 7
  s_sub_u32 s80, s38, s39
  s_lshl_b32 s44, s80, 7
  s_mul_i32 s46, s80, 172032
  s_add_u32 s45, s8, s44
  s_add_u32 s47, s9, s44
  s_add_u32 m0, s10, 49152
  s_nop 0
  buffer_load_dwordx4 v2, s[4:7], s45 offen lds
  s_add_u32 m0, s10, 50176
  s_nop 0
  buffer_load_dwordx4 v3, s[4:7], s45 offen lds
  s_add_u32 m0, s10, 51200
  s_nop 0
  buffer_load_dwordx4 v4, s[4:7], s45 offen lds
  s_add_u32 m0, s10, 52224
  s_nop 0
  buffer_load_dwordx4 v5, s[4:7], s45 offen lds
  s_add_u32 m0, s11, 65536
  s_mov_b32 exec_hi, 0
  buffer_load_dwordx4 v7, s[4:7], s47 offen lds
  s_mov_b64 exec, -1
  s_add_u32 s44, s44, 128
  s_cmp_ge_u32 s44, 896
  s_cselect_b32 s44, 0, s44
  s_add_u32 s45, s59, s46
  s_add_u32 m0, s60, 16384
  s_add_u32 s47, s45, 21504
  buffer_load_dwordx4 v6, s[16:19], s45 offen lds
  s_add_u32 m0, s60, 17408
  s_add_u32 s46, s46, 172032
  buffer_load_dwordx4 v6, s[16:19], s47 offen lds
  s_cmp_ge_u32 s46, 1204224
  s_cselect_b32 s46, 0, s46
  s_mov_b32 s12, s82
  s_mov_b32 s13, s83
  s_mov_b32 s14, 0x10000000
  s_mov_b32 s15, 0x00020000
  s_mov_b32 s0, s82
  s_mov_b32 s1, s83
  v_mov_b32 v13, 0
  buffer_load_dword v14, v13, s[12:15], 0 offen sc1
  v_and_b32 v11, 15, v1
  v_lshrrev_b32 v9, 4, v1
  v_bfe_u32 v10, v1, 1, 3
  v_xor_b32 v10, v10, v9
  v_lshlrev_b32 v10, 4, v10
  v_lshl_add_u32 v24, v11, 7, v10
  v_xor_b32 v25, 64, v24
  v_lshlrev_b32 v26, 3, v9
  v_bfe_u32 v10, v1, 2, 2
  v_add_u32 v26, v26, v10
  v_lshlrev_b32 v26, 6, v26
  v_and_b32 v10, 3, v1
  v_lshl_add_u32 v26, v10, 3, v26
  s_and_b32 s38, s35, 1
  s_lshl_b32 s38, s38, 5
  s_lshr_b32 s39, s35, 1
  s_lshl_b32 s39, s39, 12
  s_add_u32 s38, s38, s39
  v_add_u32 v26, s38, v26
  v_lshlrev_b32 v8, 4, v1
  s_mov_b32 s20, s74
  s_mov_b32 s21, s75
  s_mov_b32 s22, 0x62000
  s_mov_b32 s23, 0x00020000
  s_mov_b32 s64, s44
  s_mov_b32 s65, s46
  v_lshlrev_b32 v248, 4, v1
  s_lshl_b32 s38, s34, 10
  s_add_u32 s39, s38, 122880
  v_add_u32 v240, s39, v248
  s_add_u32 s40, s34, 1
  s_lshr_b32 s41, s40, 1
  s_lshl_b32 s41, s41, 11
  s_and_b32 s40, s40, 1
  s_lshl_b32 s40, s40, 3
  s_add_u32 s40, s40, s41
  s_add_u32 s40, s40, 132096
  v_add_u32 v241, s40, v248
  s_add_u32 s40, s34, 2
  s_lshr_b32 s41, s40, 1
  s_lshl_b32 s41, s41, 11
  s_and_b32 s40, s40, 1
  s_lshl_b32 s40, s40, 3
  s_add_u32 s40, s40, s41
  s_add_u32 s40, s40, 132096
  v_add_u32 v242, s40, v248
  v_and_b32 v48, 15, v1
  s_lshl_b32 s39, s34, 6
  s_add_u32 s39, s39, 150528
  v_lshl_add_u32 v243, v48, 2, s39
  v_mov_b32 v249, 0xff800000
  v_lshrrev_b32 v49, 4, v1
  v_lshlrev_b32 v49, 2, v49
  s_and_b32 s38, s34, 1
  s_add_u32 s39, s34, s38
  s_cmp_eq_u32 s38, 0
  s_cselect_b32 s40, 16, 0
  s_add_u32 s40, s40, s34
  s_lshl_b32 s41, s39, 10
  v_add_u32 v244, s41, v248
  s_lshl_b32 s41, s40, 10
  v_add_u32 v245, s41, v248
  s_lshr_b32 s41, s39, 1
  s_lshl_b32 s41, s41, 11
  s_add_u32 s41, s41, 24576
  v_add_u32 v246, s41, v248
  s_lshr_b32 s41, s40, 1
  s_lshl_b32 s41, s41, 11
  s_and_b32 s42, s40, 1
  s_lshl_b32 s42, s42, 3
  s_add_u32 s41, s41, s42
  s_add_u32 s41, s41, 24576
  v_add_u32 v247, s41, v248
  v_add_u32 v50, 0, v49
  v_xor_b32 v51, v48, v50
  v_and_b32 v51, 1, v51
  v_cmp_eq_u32 s[40:41], 0, v51
  v_add_u32 v51, 2, v48
  v_cmp_ge_u32 s[24:25], v50, v51
  v_cmp_le_u32 s[42:43], v50, v48
  s_nop 1
  s_and_b64 s[24:25], s[24:25], s[40:41]
  s_and_b64 s[50:51], s[42:43], s[40:41]
  s_not_b64 s[44:45], s[42:43]
  s_cmp_eq_u32 s38, 0
  s_cselect_b64 s[84:85], s[44:45], -1
  s_cselect_b64 s[92:93], -1, s[42:43]
  s_cselect_b64 s[70:71], s[42:43], s[44:45]
  v_add_u32 v50, 1, v49
  v_xor_b32 v51, v48, v50
  v_and_b32 v51, 1, v51
  v_cmp_eq_u32 s[40:41], 0, v51
  v_add_u32 v51, 2, v48
  v_cmp_ge_u32 s[26:27], v50, v51
  v_cmp_le_u32 s[42:43], v50, v48
  s_nop 1
  s_and_b64 s[26:27], s[26:27], s[40:41]
  s_and_b64 s[52:53], s[42:43], s[40:41]
  s_not_b64 s[44:45], s[42:43]
  s_cmp_eq_u32 s38, 0
  s_cselect_b64 s[86:87], s[44:45], -1
  s_cselect_b64 s[94:95], -1, s[42:43]
  s_cselect_b64 s[72:73], s[42:43], s[44:45]
  v_add_u32 v50, 2, v49
  v_xor_b32 v51, v48, v50
  v_and_b32 v51, 1, v51
  v_cmp_eq_u32 s[40:41], 0, v51
  v_add_u32 v51, 2, v48
  v_cmp_ge_u32 s[28:29], v50, v51
  v_cmp_le_u32 s[42:43], v50, v48
  s_nop 1
  s_and_b64 s[28:29], s[28:29], s[40:41]
  s_and_b64 s[54:55], s[42:43], s[40:41]
  s_not_b64 s[44:45], s[42:43]
  s_cmp_eq_u32 s38, 0
  s_cselect_b64 s[88:89], s[44:45], -1
  s_cselect_b64 s[96:97], -1, s[42:43]
  s_cselect_b64 s[76:77], s[42:43], s[44:45]
  v_add_u32 v50, 3, v49
  v_xor_b32 v51, v48, v50
  v_and_b32 v51, 1, v51
  v_cmp_eq_u32 s[40:41], 0, v51
  v_add_u32 v51, 2, v48
  v_cmp_ge_u32 s[30:31], v50, v51
  v_cmp_le_u32 s[42:43], v50, v48
  s_nop 1
  s_and_b64 s[30:31], s[30:31], s[40:41]
  s_and_b64 s[56:57], s[42:43], s[40:41]
  s_not_b64 s[44:45], s[42:43]
  s_cmp_eq_u32 s38, 0
  s_cselect_b64 s[90:91], s[44:45], -1
  s_cselect_b64 s[98:99], -1, s[42:43]
  s_cselect_b64 s[78:79], s[42:43], s[44:45]
  s_or_b32 s40, s33, s34
  s_cmp_eq_u32 s40, 0
  s_cselect_b64 s[24:25], 0, s[24:25]
  s_cselect_b64 s[26:27], 0, s[26:27]
  s_cselect_b64 s[28:29], 0, s[28:29]
  s_cselect_b64 s[30:31], 0, s[30:31]
  s_cmp_ge_u32 s32, 7
  s_cselect_b32 s100, 1, 0
  s_mul_i32 s38, s100, 7
  s_sub_u32 s101, s32, s38
  v_lshrrev_b32 v50, 3, v1
  s_mov_b32 s38, 896
  v_mul_lo_u32 v50, v50, s38
  v_bfe_u32 v51, v1, 4, 1
  v_lshlrev_b32 v51, 2, v51
  v_and_b32 v52, 7, v1
  v_xor_b32 v51, v51, v52
  v_lshl_add_u32 v250, v51, 4, v50
  s_mov_b32 s44, s64
  s_lshl_b32 s38, s32, 2
  s_lshr_b32 s39, s35, 1
  s_add_u32 s38, s38, s39
  s_mul_i32 s38, s38, 28672
  s_and_b32 s40, s35, 1
  s_lshl_b32 s40, s40, 11
  s_add_u32 s38, s38, s40
  s_add_u32 s61, s38, 0x100000
  s_lshl_b32 s39, s39, 12
  s_add_u32 s49, s39, s40
  s_add_u32 s45, s8, s44
  s_add_u32 s47, s9, s44
  s_add_u32 m0, s10, 67584
  s_nop 0
  buffer_load_dwordx4 v2, s[4:7], s45 offen lds
  s_add_u32 m0, s10, 68608
  s_nop 0
  buffer_load_dwordx4 v3, s[4:7], s45 offen lds
  s_add_u32 m0, s10, 69632
  s_nop 0
  buffer_load_dwordx4 v4, s[4:7], s45 offen lds
  s_add_u32 m0, s10, 70656
  s_nop 0
  buffer_load_dwordx4 v5, s[4:7], s45 offen lds
  s_add_u32 m0, s11, 83968
  s_mov_b32 exec_hi, 0
  buffer_load_dwordx4 v7, s[4:7], s47 offen lds
  s_mov_b64 exec, -1
  s_add_u32 s44, s44, 128
  s_cmp_ge_u32 s44, 896
  s_cselect_b32 s44, 0, s44
  s_add_u32 s45, s59, s46
  s_add_u32 m0, s60, 26624
  s_add_u32 s47, s45, 21504
  buffer_load_dwordx4 v6, s[16:19], s45 offen lds
  s_add_u32 m0, s60, 27648
  s_add_u32 s46, s46, 172032
  buffer_load_dwordx4 v6, s[16:19], s47 offen lds
  s_cmp_ge_u32 s46, 1204224
  s_cselect_b32 s46, 0, s46
  s_waitcnt vmcnt(8)
  s_barrier
  s_add_u32 s45, s8, s44
  s_add_u32 s47, s9, s44
  s_add_u32 m0, s10, 86016
  s_nop 0
  buffer_load_dwordx4 v2, s[4:7], s45 offen lds
  s_add_u32 m0, s10, 87040
  s_nop 0
  buffer_load_dwordx4 v3, s[4:7], s45 offen lds
  s_add_u32 m0, s10, 88064
  s_nop 0
  buffer_load_dwordx4 v4, s[4:7], s45 offen lds
  s_add_u32 m0, s10, 89088
  s_nop 0
  buffer_load_dwordx4 v5, s[4:7], s45 offen lds
  s_add_u32 m0, s11, 102400
  s_mov_b32 exec_hi, 0
  buffer_load_dwordx4 v7, s[4:7], s47 offen lds
  s_mov_b64 exec, -1
  s_add_u32 s44, s44, 128
  s_cmp_ge_u32 s44, 896
  s_cselect_b32 s44, 0, s44
  s_add_u32 s45, s59, s46
  s_add_u32 m0, s60, 34816
  s_add_u32 s47, s45, 21504
  buffer_load_dwordx4 v6, s[16:19], s45 offen lds
  s_add_u32 m0, s60, 35840
  s_add_u32 s46, s46, 172032
  buffer_load_dwordx4 v6, s[16:19], s47 offen lds
  s_cmp_ge_u32 s46, 1204224
  s_cselect_b32 s46, 0, s46
  s_add_u32 s45, s8, s44
  s_add_u32 s47, s9, s44
  s_add_u32 m0, s10, 104448
  s_nop 0
  buffer_load_dwordx4 v2, s[4:7], s45 offen lds
  s_add_u32 m0, s10, 105472
  s_nop 0
  buffer_load_dwordx4 v3, s[4:7], s45 offen lds
  s_add_u32 m0, s10, 106496
  s_nop 0
  buffer_load_dwordx4 v4, s[4:7], s45 offen lds
  s_add_u32 m0, s10, 107520
  s_nop 0
  buffer_load_dwordx4 v5, s[4:7], s45 offen lds
  s_add_u32 m0, s11, 120832
  s_mov_b32 exec_hi, 0
  buffer_load_dwordx4 v7, s[4:7], s47 offen lds
  s_mov_b64 exec, -1
  s_add_u32 s44, s44, 128
  s_cmp_ge_u32 s44, 896
  s_cselect_b32 s44, 0, s44
  v_add_u32 v9, 65536, v24
  v_add_u32 v10, 65536, v25
  ds_read_b128 v[64:67], v9
  ds_read_b128 v[68:71], v10
  s_waitcnt vmcnt(12)
  s_waitcnt lgkmcnt(0)
  s_barrier
  s_add_u32 s45, s8, s44
  s_add_u32 s47, s9, s44
  s_add_u32 m0, s10, 122880
  s_nop 0
  buffer_load_dwordx4 v2, s[4:7], s45 offen lds
  s_add_u32 m0, s10, 123904
  s_nop 0
  buffer_load_dwordx4 v3, s[4:7], s45 offen lds
  s_add_u32 m0, s10, 124928
  s_nop 0
  buffer_load_dwordx4 v4, s[4:7], s45 offen lds
  s_add_u32 m0, s10, 125952
  s_nop 0
  buffer_load_dwordx4 v5, s[4:7], s45 offen lds
  s_add_u32 m0, s11, 139264
  s_mov_b32 exec_hi, 0
  buffer_load_dwordx4 v7, s[4:7], s47 offen lds
  s_mov_b64 exec, -1
  s_add_u32 s44, s44, 128
  s_cmp_ge_u32 s44, 896
  s_cselect_b32 s44, 0, s44
  s_add_u32 s45, s8, s44
  s_add_u32 s47, s9, s44
  s_add_u32 m0, s10, 141312
  s_nop 0
  buffer_load_dwordx4 v2, s[4:7], s45 offen lds
  s_add_u32 m0, s10, 142336
  s_nop 0
  buffer_load_dwordx4 v3, s[4:7], s45 offen lds
  s_add_u32 m0, s10, 143360
  s_nop 0
  buffer_load_dwordx4 v4, s[4:7], s45 offen lds
  s_add_u32 m0, s10, 144384
  s_nop 0
  buffer_load_dwordx4 v5, s[4:7], s45 offen lds
  s_add_u32 m0, s11, 157696
  s_mov_b32 exec_hi, 0
  buffer_load_dwordx4 v7, s[4:7], s47 offen lds
  s_mov_b64 exec, -1
  s_add_u32 s44, s44, 128
  s_cmp_ge_u32 s44, 896
  s_cselect_b32 s44, 0, s44
  v_add_u32 v9, 83968, v24
  v_add_u32 v10, 83968, v25
  ds_read_b128 v[72:75], v9
  ds_read_b128 v[76:79], v10
  s_waitcnt vmcnt(15)
  s_waitcnt lgkmcnt(0)
  v_readfirstlane_b32 s36, v14
  s_nop 3
  s_mul_i32 s36, s36, 0x9E3779B1
  s_add_u32 s36, s36, 0x7F4A7C15
  s_barrier
  s_add_u32 s45, s8, s44
  s_add_u32 s47, s9, s44
  s_add_u32 m0, s10, 0
  s_nop 0
  buffer_load_dwordx4 v2, s[4:7], s45 offen lds
  s_add_u32 m0, s10, 1024
  s_nop 0
  buffer_load_dwordx4 v3, s[4:7], s45 offen lds
  s_add_u32 m0, s10, 2048
  s_nop 0
  buffer_load_dwordx4 v4, s[4:7], s45 offen lds
  s_add_u32 m0, s10, 3072
  s_nop 0
  buffer_load_dwordx4 v5, s[4:7], s45 offen lds
  s_add_u32 m0, s11, 24576
  s_mov_b32 exec_hi, 0
  buffer_load_dwordx4 v7, s[4:7], s47 offen lds
  s_mov_b64 exec, -1
  s_add_u32 s44, s44, 128
  s_cmp_ge_u32 s44, 896
  s_cselect_b32 s44, 0, s44
  s_add_u32 s45, s59, s46
  s_add_u32 m0, s60, 49152
  s_add_u32 s47, s45, 21504
  buffer_load_dwordx4 v6, s[16:19], s45 offen lds
  s_add_u32 m0, s60, 50176
  s_add_u32 s46, s46, 172032
  buffer_load_dwordx4 v6, s[16:19], s47 offen lds
  s_cmp_ge_u32 s46, 1204224
  s_cselect_b32 s46, 0, s46
  s_add_u32 s45, s59, s46
  s_add_u32 m0, s60, 57344
  s_add_u32 s47, s45, 21504
  buffer_load_dwordx4 v6, s[16:19], s45 offen lds
  s_add_u32 m0, s60, 58368
  s_add_u32 s46, s46, 172032
  buffer_load_dwordx4 v6, s[16:19], s47 offen lds
  s_cmp_ge_u32 s46, 1204224
  s_cselect_b32 s46, 0, s46
  v_add_u32 v9, 102400, v24
  v_add_u32 v10, 102400, v25
  ds_read_b128 v[80:83], v9
  ds_read_b128 v[84:87], v10
  s_waitcnt vmcnt(2)
  s_waitcnt lgkmcnt(0)
  s_barrier
  s_add_u32 s45, s59, s46
  s_add_u32 m0, s60, 67584
  s_add_u32 s47, s45, 21504
  buffer_load_dwordx4 v6, s[16:19], s45 offen lds
  s_add_u32 m0, s60, 68608
  s_add_u32 s46, s46, 172032
  buffer_load_dwordx4 v6, s[16:19], s47 offen lds
  s_cmp_ge_u32 s46, 1204224
  s_cselect_b32 s46, 0, s46
  s_add_u32 s45, s59, s46
  s_add_u32 m0, s60, 75776
  s_add_u32 s47, s45, 21504
  buffer_load_dwordx4 v6, s[16:19], s45 offen lds
  s_add_u32 m0, s60, 76800
  s_add_u32 s46, s46, 172032
  buffer_load_dwordx4 v6, s[16:19], s47 offen lds
  s_cmp_ge_u32 s46, 1204224
  s_cselect_b32 s46, 0, s46
  s_lshl_b32 s38, s32, 11
  s_lshr_b32 s39, s35, 1
  s_lshl_b32 s39, s39, 15
  s_add_u32 s38, s38, s39
  s_add_u32 s38, s38, 0x30000
  v_and_b32 v17, 15, v1
  v_lshlrev_b32 v17, 7, v17
  v_bfe_u32 v18, v1, 4, 1
  v_lshlrev_b32 v18, 16, v18
  v_add_u32 v17, v17, v18
  v_add_u32 v17, s38, v17
  buffer_load_dword v18, v17, s[12:15], 0 offen sc1
  s_lshl_b32 s3, s80, 12
  s_mov_b32 s59, s3
  v_add_u32 v9, 120832, v24
  v_add_u32 v10, 120832, v25
  ds_read_b128 v[88:91], v9
  ds_read_b128 v[92:95], v10
  s_waitcnt vmcnt(5)
  s_waitcnt lgkmcnt(0)
  s_barrier
  s_lshr_b32 s38, s35, 1
  s_add_u32 s39, s33, s38
  s_sub_u32 s39, s39, 2
  s_lshl_b32 s45, s39, 4
  s_add_u32 s41, s45, s32
  s_lshl_b32 s40, s41, 14
  s_add_u32 s40, s40, 0x400000
  s_and_b32 s47, s35, 1
  s_lshl_b32 s41, s47, 13
  s_add_u32 s40, s40, s41
  s_mul_i32 s65, s47, 24576
  s_lshl_b32 s41, s38, 13
  s_add_u32 s65, s65, s41
  s_and_b32 s41, s32, 14
  s_or_b32 s41, s41, s47
  s_add_u32 s45, s45, s41
  s_xor_b32 s11, s48, 1
  s_cmp_lt_i32 s39, 0
  s_cselect_b32 s64, 0x20000000, s40
  s_cselect_b32 s45, s11, s45
  s_lshl_b32 s45, s45, 7
  s_add_u32 s45, s45, 0x18000
  s_lshl_b32 s11, s11, 7
  s_add_u32 s11, s11, 0x18000
  v_mov_b32 v23, s11
  v_mov_b32 v19, s45
  v_cmp_eq_u32 vcc, 0, v1
  s_nop 1
  v_cndmask_b32 v23, v23, v19, vcc
  s_add_u32 s8, s0, s45
  s_addc_u32 s9, s1, 0
  s_add_u32 s82, s0, s11
  s_addc_u32 s83, s1, 0
  s_and_b32 s38, s32, 1
  s_xor_b32 s38, s38, 1
  s_lshl_b32 s42, s48, 14
  s_add_u32 s42, s42, 0x400000
  s_lshl_b32 s39, s38, 13
  s_add_u32 s42, s42, s39
  s_lshl_b32 s39, s35, 11
  s_add_u32 s42, s42, s39
  s_mul_i32 s43, s38, 24576
  s_add_u32 s43, s43, 16384
  s_add_u32 s43, s43, s39
  s_mov_b32 s58, 0
  v_add_u32 v9, 139264, v24
  v_add_u32 v10, 139264, v25
  ds_read_b128 v[96:99], v9
  ds_read_b128 v[100:103], v10
  s_waitcnt vmcnt(3)
  s_waitcnt lgkmcnt(0)
  s_barrier
  s_waitcnt vmcnt(0)
  s_mov_b32 s38, 0
L_pkl_5:
  v_cmp_ne_u32 vcc, s36, v18
  s_nop 1
  s_and_b32 vcc_lo, vcc_lo, -1
  s_cbranch_scc0 L_pkok_4
  s_add_u32 s38, s38, 1
  s_cmp_gt_u32 s38, 30000
  s_cbranch_scc1 L_pkok_4
  buffer_load_dword v18, v17, s[12:15], 0 offen sc1
  s_waitcnt vmcnt(0)
  s_branch L_pkl_5
L_pkok_4:
  s_add_u32 s38, s61, s3
  s_add_u32 m0, s49, 86016
  s_nop 0
  buffer_load_dwordx4 v8, s[12:15], s38 offen offset:0 sc1 lds
  buffer_load_dwordx4 v8, s[12:15], s38 offen offset:1024 sc1 lds
  s_add_u32 s3, s3, 4096
  s_cmp_ge_u32 s3, 28672
  s_cselect_b32 s3, 0, s3
  s_add_u32 s38, s61, s3
  s_add_u32 m0, s49, 94208
  s_nop 0
  buffer_load_dwordx4 v8, s[12:15], s38 offen offset:0 sc1 lds
  buffer_load_dwordx4 v8, s[12:15], s38 offen offset:1024 sc1 lds
  s_add_u32 s3, s3, 4096
  s_cmp_ge_u32 s3, 28672
  s_cselect_b32 s3, 0, s3
  s_add_u32 s38, s61, s3
  s_add_u32 m0, s49, 104448
  s_nop 0
  buffer_load_dwordx4 v8, s[12:15], s38 offen offset:0 sc1 lds
  buffer_load_dwordx4 v8, s[12:15], s38 offen offset:1024 sc1 lds
  s_add_u32 s3, s3, 4096
  s_cmp_ge_u32 s3, 28672
  s_cselect_b32 s3, 0, s3
  v_add_u32 v9, 157696, v24
  v_add_u32 v10, 157696, v25
  ds_read_b128 v[104:107], v9
  ds_read_b128 v[108:111], v10
  s_waitcnt vmcnt(7)
  s_waitcnt lgkmcnt(0)
  s_barrier
  s_add_u32 s38, s61, s3
  s_add_u32 m0, s49, 112640
  s_nop 0
  buffer_load_dwordx4 v8, s[12:15], s38 offen offset:0 sc1 lds
  buffer_load_dwordx4 v8, s[12:15], s38 offen offset:1024 sc1 lds
  s_add_u32 s3, s3, 4096
  s_cmp_ge_u32 s3, 28672
  s_cselect_b32 s3, 0, s3
  s_add_u32 s38, s61, s3
  s_add_u32 m0, s49, 122880
  s_nop 0
  buffer_load_dwordx4 v8, s[12:15], s38 offen offset:0 sc1 lds
  buffer_load_dwordx4 v8, s[12:15], s38 offen offset:1024 sc1 lds
  s_add_u32 s3, s3, 4096
  s_cmp_ge_u32 s3, 28672
  s_cselect_b32 s3, 0, s3
  v_add_u32 v9, 24576, v24
  v_add_u32 v10, 24576, v25
  ds_read_b128 v[112:115], v9
  ds_read_b128 v[116:119], v10
  s_waitcnt vmcnt(8)
  s_waitcnt lgkmcnt(0)
  s_barrier
  s_add_u32 s38, s61, s3
  s_add_u32 m0, s49, 131072
  s_nop 0
  buffer_load_dwordx4 v8, s[12:15], s38 offen offset:0 sc1 lds
  buffer_load_dwordx4 v8, s[12:15], s38 offen offset:1024 sc1 lds
  s_add_u32 s3, s3, 4096
  s_cmp_ge_u32 s3, 28672
  s_cselect_b32 s3, 0, s3
  s_add_u32 s38, s61, s3
  s_add_u32 m0, s49, 141312
  s_nop 0
  buffer_load_dwordx4 v8, s[12:15], s38 offen offset:0 sc1 lds
  buffer_load_dwordx4 v8, s[12:15], s38 offen offset:1024 sc1 lds
  s_add_u32 s3, s3, 4096
  s_cmp_ge_u32 s3, 28672
  s_cselect_b32 s3, 0, s3
  s_waitcnt vmcnt(10)
  s_waitcnt lgkmcnt(0)
  s_barrier
  s_add_u32 s38, s61, s59
  s_add_u32 m0, s49, 49152
  s_add_u32 s38, s38, 57344
  buffer_load_dwordx4 v8, s[12:15], s38 offen offset:0 sc1 lds
  buffer_load_dwordx4 v8, s[12:15], s38 offen offset:1024 sc1 lds
  s_add_u32 s59, s59, 4096
  s_cmp_ge_u32 s59, 28672
  s_cselect_b32 s59, 0, s59
  s_add_u32 s38, s61, s59
  s_add_u32 m0, s49, 57344
  s_add_u32 s38, s38, 57344
  buffer_load_dwordx4 v8, s[12:15], s38 offen offset:0 sc1 lds
  buffer_load_dwordx4 v8, s[12:15], s38 offen offset:1024 sc1 lds
  s_add_u32 s59, s59, 4096
  s_cmp_ge_u32 s59, 28672
  s_cselect_b32 s59, 0, s59
  s_add_u32 s38, s61, s59
  s_add_u32 m0, s49, 67584
  s_add_u32 s38, s38, 57344
  buffer_load_dwordx4 v8, s[12:15], s38 offen offset:0 sc1 lds
  buffer_load_dwordx4 v8, s[12:15], s38 offen offset:1024 sc1 lds
  s_add_u32 s59, s59, 4096
  s_cmp_ge_u32 s59, 28672
  s_cselect_b32 s59, 0, s59
  s_waitcnt vmcnt(14)
  s_waitcnt lgkmcnt(0)
  s_barrier
  s_add_u32 s38, s61, s59
  s_add_u32 m0, s49, 75776
  s_add_u32 s38, s38, 57344
  buffer_load_dwordx4 v8, s[12:15], s38 offen offset:0 sc1 lds
  buffer_load_dwordx4 v8, s[12:15], s38 offen offset:1024 sc1 lds
  s_add_u32 s59, s59, 4096
  s_cmp_ge_u32 s59, 28672
  s_cselect_b32 s59, 0, s59
  s_add_u32 s38, s61, s59
  s_add_u32 m0, s49, 86016
  s_add_u32 s38, s38, 57344
  buffer_load_dwordx4 v8, s[12:15], s38 offen offset:0 sc1 lds
  buffer_load_dwordx4 v8, s[12:15], s38 offen offset:1024 sc1 lds
  s_add_u32 s59, s59, 4096
  s_cmp_ge_u32 s59, 28672
  s_cselect_b32 s59, 0, s59
  s_waitcnt vmcnt(16)
  s_waitcnt lgkmcnt(0)
  s_barrier
  s_add_u32 s38, s61, s59
  s_add_u32 m0, s49, 94208
  s_add_u32 s38, s38, 57344
  buffer_load_dwordx4 v8, s[12:15], s38 offen offset:0 sc1 lds
  buffer_load_dwordx4 v8, s[12:15], s38 offen offset:1024 sc1 lds
  s_add_u32 s59, s59, 4096
  s_cmp_ge_u32 s59, 28672
  s_cselect_b32 s59, 0, s59
  s_cmp_lg_u32 s34, 4
  s_cbranch_scc1 L_kvf_6
  s_lshl_b32 s38, s48, 7
  s_add_u32 s38, s38, 0x18000
  v_mov_b32 v252, s36
  v_mov_b32 v251, 0
  s_mov_b64 exec, 1
  buffer_store_dword v252, v251, s[12:15], s38 offen sc1
  s_mov_b64 exec, -1
L_kvf_6:
  s_waitcnt vmcnt(16)
  s_waitcnt lgkmcnt(0)
  s_barrier
  s_add_u32 s38, s61, s59
  s_add_u32 m0, s49, 104448
  s_add_u32 s38, s38, 57344
  buffer_load_dwordx4 v8, s[12:15], s38 offen offset:0 sc1 lds
  buffer_load_dwordx4 v8, s[12:15], s38 offen offset:1024 sc1 lds
  s_add_u32 s59, s59, 4096
  s_cmp_ge_u32 s59, 28672
  s_cselect_b32 s59, 0, s59
  s_waitcnt vmcnt(16)
  s_waitcnt lgkmcnt(0)
  s_barrier
  s_waitcnt vmcnt(14)
  s_waitcnt lgkmcnt(0)
  s_barrier
  s_waitcnt vmcnt(0)
  s_waitcnt lgkmcnt(0)
  s_barrier
  s_lshr_b32 s38, s2, 3
  s_cmp_ge_u32 s38, 16
  s_cselect_b32 s20, s68, s74
  s_cselect_b32 s21, s69, s75
  s_and_b32 s38, s38, 15
  s_mul_i32 s38, s38, 25088
  s_mul_i32 s39, s35, 6272
  s_add_u32 s38, s38, s39
  v_lshlrev_b32 v27, 7, v1
  buffer_load_dword v28, v27, s[20:23], s38 offen
  v_add_u32 v10, 49152, v26
  ds_read_b64_tr_b16 v[128:129], v10 offset:0
  ds_read_b64_tr_b16 v[130:131], v10 offset:256
  ds_read_b64_tr_b16 v[132:133], v10 offset:2048
  ds_read_b64_tr_b16 v[134:135], v10 offset:2304
  v_add_u32 v10, 57344, v26
  ds_read_b64_tr_b16 v[136:137], v10 offset:0
  ds_read_b64_tr_b16 v[138:139], v10 offset:256
  ds_read_b64_tr_b16 v[140:141], v10 offset:2048
  ds_read_b64_tr_b16 v[142:143], v10 offset:2304
  v_add_u32 v10, 67584, v26
  ds_read_b64_tr_b16 v[144:145], v10 offset:0
  ds_read_b64_tr_b16 v[146:147], v10 offset:256
  ds_read_b64_tr_b16 v[148:149], v10 offset:2048
  ds_read_b64_tr_b16 v[150:151], v10 offset:2304
  v_add_u32 v10, 75776, v26
  ds_read_b64_tr_b16 v[152:153], v10 offset:0
  ds_read_b64_tr_b16 v[154:155], v10 offset:256
  ds_read_b64_tr_b16 v[156:157], v10 offset:2048
  ds_read_b64_tr_b16 v[158:159], v10 offset:2304
  v_add_u32 v10, 86016, v26
  ds_read_b64_tr_b16 v[160:161], v10 offset:0
  ds_read_b64_tr_b16 v[162:163], v10 offset:256
  ds_read_b64_tr_b16 v[164:165], v10 offset:2048
  ds_read_b64_tr_b16 v[166:167], v10 offset:2304
  v_add_u32 v10, 94208, v26
  ds_read_b64_tr_b16 v[168:169], v10 offset:0
  ds_read_b64_tr_b16 v[170:171], v10 offset:256
  ds_read_b64_tr_b16 v[172:173], v10 offset:2048
  ds_read_b64_tr_b16 v[174:175], v10 offset:2304
  v_add_u32 v10, 104448, v26
  ds_read_b64_tr_b16 v[176:177], v10 offset:0
  ds_read_b64_tr_b16 v[178:179], v10 offset:256
  ds_read_b64_tr_b16 v[180:181], v10 offset:2048
  ds_read_b64_tr_b16 v[182:183], v10 offset:2304
  s_cmp_lg_u32 s58, 0
  s_cbranch_scc1 L_kvd_7
  s_mov_b32 s38, 0
L_kvl_8:
  s_load_dword s10, s[8:9], 0 glc
  s_load_dword s37, s[82:83], 0 glc
  s_add_u32 s38, s38, 1
  s_waitcnt lgkmcnt(0)
  s_cmp_gt_u32 s38, 100000
  s_cbranch_scc1 L_kvn_9
  s_xor_b32 s10, s10, s36
  s_xor_b32 s37, s37, s36
  s_or_b32 s10, s10, s37
  s_cmp_lg_u32 s10, 0
  s_cbranch_scc1 L_kvl_8
L_kvn_9:
  s_add_u32 m0, s65, 0
  s_nop 0
  buffer_load_dwordx4 v248, s[12:15], s64 offen offset:0 sc1 lds
  s_add_u32 m0, s65, 0
  s_nop 0
  buffer_load_dwordx4 v248, s[12:15], s64 offen offset:1024 sc1 lds
  s_add_u32 m0, s65, 0
  s_nop 0
  buffer_load_dwordx4 v248, s[12:15], s64 offen offset:2048 sc1 lds
  s_add_u32 m0, s65, 0
  s_nop 0
  buffer_load_dwordx4 v248, s[12:15], s64 offen offset:3072 sc1 lds
  s_add_u32 m0, s65, 4096
  s_add_u32 s64, s64, 4096
  buffer_load_dwordx4 v248, s[12:15], s64 offen offset:0 sc1 lds
  s_add_u32 m0, s65, 4096
  s_nop 0
  buffer_load_dwordx4 v248, s[12:15], s64 offen offset:1024 sc1 lds
  s_add_u32 m0, s65, 4096
  s_nop 0
  buffer_load_dwordx4 v248, s[12:15], s64 offen offset:2048 sc1 lds
  s_add_u32 m0, s65, 4096
  s_nop 0
  buffer_load_dwordx4 v248, s[12:15], s64 offen offset:3072 sc1 lds
  s_mov_b32 m0, s43
  s_nop 0
  buffer_load_dwordx4 v248, s[12:15], s42 offen offset:0 sc1 lds
  buffer_load_dwordx4 v248, s[12:15], s42 offen offset:1024 sc1 lds
  s_mov_b32 s58, 1
L_kvd_7:
  s_mov_b32 s16, s78
  s_mov_b32 s17, s79
  s_mov_b32 s18, 0x1c0000
  s_mov_b32 s19, 0x00020000
  s_lshl_b32 s38, s33, 3
  s_add_u32 s38, s38, s34
  s_lshl_b32 s38, s38, 4
  s_add_u32 s38, s38, s32
  s_lshl_b32 s39, s38, 10
  s_add_u32 s60, s39, 0xa00000
  s_add_u32 s61, s39, 0x800000
  s_lshl_b32 s39, s48, 7
  s_add_u32 s49, s39, 0x20000
  s_add_u32 s59, s39, 0x28000
  s_mul_i32 s46, s34, 50176
  s_lshl_b32 s38, s101, 7
  s_add_u32 s46, s46, s38
  s_cmp_ge_u32 s32, 14
  s_cselect_b32 s46, 0x20000000, s46
  s_mul_i32 s47, s34, 7168
  s_mov_b32 s20, s74
  s_mov_b32 s21, s75
  s_waitcnt lgkmcnt(0)
  s_cmp_ge_u32 s35, 2
  s_cbranch_scc1 L_hv_10
  v_mfma_f32_16x16x32_bf16 v[32:35], v[128:131], v[64:67], 0
  v_mfma_f32_16x16x32_bf16 v[32:35], v[132:135], v[68:71], v[32:35]
  v_mfma_f32_16x16x32_bf16 v[32:35], v[136:139], v[72:75], v[32:35]
  v_mfma_f32_16x16x32_bf16 v[32:35], v[140:143], v[76:79], v[32:35]
  v_mfma_f32_16x16x32_bf16 v[32:35], v[144:147], v[80:83], v[32:35]
  v_mfma_f32_16x16x32_bf16 v[32:35], v[148:151], v[84:87], v[32:35]
  v_mfma_f32_16x16x32_bf16 v[32:35], v[152:155], v[88:91], v[32:35]
  v_mfma_f32_16x16x32_bf16 v[32:35], v[156:159], v[92:95], v[32:35]
  v_mfma_f32_16x16x32_bf16 v[32:35], v[160:163], v[96:99], v[32:35]
  v_mfma_f32_16x16x32_bf16 v[32:35], v[164:167], v[100:103], v[32:35]
  v_mfma_f32_16x16x32_bf16 v[32:35], v[168:171], v[104:107], v[32:35]
  v_mfma_f32_16x16x32_bf16 v[32:35], v[172:175], v[108:111], v[32:35]
  v_mfma_f32_16x16x32_bf16 v[32:35], v[176:179], v[112:115], v[32:35]
  v_mfma_f32_16x16x32_bf16 v[32:35], v[180:183], v[116:119], v[32:35]
  s_branch L_he_11
L_hv_10:
  v_mfma_f32_16x16x32_bf16 v[32:35], v[64:67], v[128:131], 0
  v_mfma_f32_16x16x32_bf16 v[32:35], v[68:71], v[132:135], v[32:35]
  v_mfma_f32_16x16x32_bf16 v[32:35], v[72:75], v[136:139], v[32:35]
  v_mfma_f32_16x16x32_bf16 v[32:35], v[76:79], v[140:143], v[32:35]
  v_mfma_f32_16x16x32_bf16 v[32:35], v[80:83], v[144:147], v[32:35]
  v_mfma_f32_16x16x32_bf16 v[32:35], v[84:87], v[148:151], v[32:35]
  v_mfma_f32_16x16x32_bf16 v[32:35], v[88:91], v[152:155], v[32:35]
  v_mfma_f32_16x16x32_bf16 v[32:35], v[92:95], v[156:159], v[32:35]
  v_mfma_f32_16x16x32_bf16 v[32:35], v[96:99], v[160:163], v[32:35]
  v_mfma_f32_16x16x32_bf16 v[32:35], v[100:103], v[164:167], v[32:35]
  v_mfma_f32_16x16x32_bf16 v[32:35], v[104:107], v[168:171], v[32:35]
  v_mfma_f32_16x16x32_bf16 v[32:35], v[108:111], v[172:175], v[32:35]
  v_mfma_f32_16x16x32_bf16 v[32:35], v[112:115], v[176:179], v[32:35]
  v_mfma_f32_16x16x32_bf16 v[32:35], v[116:119], v[180:183], v[32:35]
L_he_11:
  v_lshrrev_b32 v10, 4, v1
  v_and_b32 v11, 15, v1
  s_and_b32 s38, s35, 1
  s_nop 4
  v_cvt_pk_bf16_f32 v8, v32, v33
  v_cvt_pk_bf16_f32 v9, v34, v35
  s_cmp_ge_u32 s35, 2
  s_cbranch_scc1 L_hev_12
  v_and_b32 v12, 1, v10
  v_lshlrev_b32 v12, 8, v12
  v_lshl_add_u32 v12, v11, 4, v12
  v_lshrrev_b32 v13, 1, v10
  v_lshl_add_u32 v12, v13, 3, v12
  s_lshl_b32 s39, s38, 9
  s_add_u32 s39, s39, 122880
  v_add_u32 v12, s39, v12
  s_lshl_b32 s39, s38, 2
  v_add_u32 v13, s39, v10
  v_cmp_eq_u32 vcc, 7, v13
  v_mov_b32 v13, 0
  s_nop 0
  v_cndmask_b32 v8, v8, v13, vcc
  v_cndmask_b32 v9, v9, v13, vcc
  ds_write_b64 v12, v[8:9]
  s_branch L_hee_13
L_hev_12:
  v_lshlrev_b32 v12, 8, v10
  v_lshl_add_u32 v12, v11, 4, v12
  s_lshl_b32 s39, s38, 10
  s_add_u32 s39, s39, 132104
  v_add_u32 v12, s39, v12
  s_lshl_b32 s39, s38, 4
  v_add_u32 v13, s39, v11
  v_cmp_eq_u32 vcc, 28, v13
  v_mov_b32 v13, 0x3f803f80
  s_nop 0
  v_cndmask_b32 v8, v8, v13, vcc
  v_cndmask_b32 v9, v9, v13, vcc
  ds_write_b64 v12, v[8:9]
L_hee_13:
  s_waitcnt vmcnt(0) lgkmcnt(0)
  s_cmp_lg_u32 s64, 0x20001000
  s_cbranch_scc1 L_absk_14
  s_and_b32 s38, s35, 1
  s_cmp_lg_u32 s38, 0
  s_cbranch_scc1 L_absk_14
  v_lshrrev_b32 v12, 4, v1
  v_lshlrev_b32 v12, 10, v12
  v_and_b32 v13, 15, v1
  v_lshl_add_u32 v12, v13, 4, v12
  v_add_u32 v12, s65, v12
  v_mov_b32 v13, 0x0000ff7f
  ds_write_b32 v12, v13 offset:776
  ds_write_b32 v12, v13 offset:4872
  s_waitcnt lgkmcnt(0)
L_absk_14:
L_attn:
  s_cmp_lt_u32 s34, 4
  s_cbranch_scc1 L_pr_15
  s_setprio 1
L_pr_15:
  s_barrier
  ds_read_b128 v[8:11], v240 offset:19456
  ds_read_b128 v[148:151], v240
  ds_read_b128 v[152:155], v240 offset:1024
  ds_read_b128 v[4:7], v240 offset:32768
  ds_read_b128 v[100:103], v244 offset:0
  ds_read_b128 v[104:107], v244 offset:1024
  ds_read_b128 v[108:111], v244 offset:2048
  ds_read_b128 v[112:115], v244 offset:3072
  ds_read_b64 v[164:165], v241 offset:0
  ds_read_b64 v[168:169], v241 offset:1024
  ds_read_b64 v[166:167], v242 offset:0
  ds_read_b64 v[170:171], v242 offset:1024
  ds_read_b32 v12, v243
  s_waitcnt lgkmcnt(10)
  v_mfma_f32_16x16x32_bf16 v[140:143], v[148:151], v[8:11], 0
  v_mfma_f32_16x16x32_bf16 v[144:147], v[152:155], v[8:11], 0
  s_waitcnt lgkmcnt(8)
  v_mfma_f32_16x16x32_bf16 v[32:35], v[100:103], v[4:7], 0
  ds_read_b128 v[100:103], v244 offset:4096
  s_add_u32 m0, s47, 49152
  s_add_u32 s45, s46, 0
  buffer_load_dwordx4 v250, s[20:23], s45 offen lds
  s_waitcnt lgkmcnt(8)
  v_mfma_f32_16x16x32_bf16 v[36:39], v[104:107], v[4:7], 0
  ds_read_b128 v[104:107], v244 offset:5120
  v_cndmask_b32 v140, v249, v140, s[24:25]
  v_cndmask_b32 v141, v249, v141, s[26:27]
  v_cndmask_b32 v142, v249, v142, s[28:29]
  v_cndmask_b32 v143, v249, v143, s[30:31]
  v_cndmask_b32 v144, v249, v144, s[50:51]
  v_cndmask_b32 v145, v249, v145, s[52:53]
  v_cndmask_b32 v146, v249, v146, s[54:55]
  v_cndmask_b32 v147, v249, v147, s[56:57]
  v_max3_f32 v172, v140, v141, v142
  v_max3_f32 v174, v143, v144, v145
  v_max3_f32 v172, v172, v146, v147
  v_max_f32 v172, v172, v174
  v_mov_b32 v174, v172
  s_add_u32 m0, s47, 50176
  s_add_u32 s45, s46, 7168
  buffer_load_dwordx4 v250, s[20:23], s45 offen lds
  v_permlane32_swap_b32 v172, v174
  s_waitcnt lgkmcnt(8)
  v_mfma_f32_16x16x32_bf16 v[40:43], v[108:111], v[4:7], 0
  ds_read_b128 v[108:111], v244 offset:6144
  v_max_f32 v172, v172, v174
  v_mov_b32 v174, v172
  s_add_u32 m0, s47, 51200
  s_add_u32 s45, s46, 14336
  buffer_load_dwordx4 v250, s[20:23], s45 offen lds
  v_permlane16_swap_b32 v172, v174
  s_waitcnt lgkmcnt(8)
  v_mfma_f32_16x16x32_bf16 v[44:47], v[112:115], v[4:7], 0
  ds_read_b128 v[112:115], v244 offset:7168
  v_max_f32 v172, v172, v174
  v_sub_f32 v172, 0, v172
  v_mov_b32 v173, v172
  v_pk_add_f32 v[140:141], v[140:141], v[172:173]
  v_pk_add_f32 v[142:143], v[142:143], v[172:173]
  v_pk_add_f32 v[144:145], v[144:145], v[172:173]
  v_pk_add_f32 v[146:147], v[146:147], v[172:173]
  v_exp_f32 v140, v140
  v_exp_f32 v141, v141
  v_exp_f32 v142, v142
  v_exp_f32 v143, v143
  v_exp_f32 v144, v144
  v_exp_f32 v145, v145
  v_exp_f32 v146, v146
  v_exp_f32 v147, v147
  v_cvt_pk_bf16_f32 v140, v140, v141
  v_cvt_pk_bf16_f32 v141, v142, v143
  v_cvt_pk_bf16_f32 v142, v144, v145
  v_cvt_pk_bf16_f32 v143, v146, v147
  s_waitcnt lgkmcnt(5)
  s_waitcnt lgkmcnt(4)
  v_sub_f32 v13, 1.0, v12
  s_nop 0
  v_mfma_f32_16x16x32_bf16 v[156:159], v[164:167], v[140:143], 0
  v_mfma_f32_16x16x32_bf16 v[160:163], v[168:171], v[140:143], 0
  s_add_u32 m0, s47, 52224
  s_add_u32 s45, s46, 21504
  buffer_load_dwordx4 v250, s[20:23], s45 offen lds
  s_waitcnt lgkmcnt(3)
  v_mfma_f32_16x16x32_bf16 v[48:51], v[100:103], v[4:7], 0
  ds_read_b128 v[100:103], v244 offset:8192
  s_add_u32 m0, s47, 53248
  s_add_u32 s45, s46, 28672
  buffer_load_dwordx4 v250, s[20:23], s45 offen lds
  v_mov_b32 v176, v160
  v_mov_b32 v177, v160
  s_waitcnt lgkmcnt(3)
  v_mfma_f32_16x16x32_bf16 v[52:55], v[104:107], v[4:7], 0
  ds_read_b128 v[104:107], v244 offset:9216
  v_permlane32_swap_b32 v176, v177
  s_add_u32 m0, s47, 54272
  s_add_u32 s45, s46, 35840
  buffer_load_dwordx4 v250, s[20:23], s45 offen lds
  v_mov_b32 v176, v177
  s_waitcnt lgkmcnt(3)
  v_mfma_f32_16x16x32_bf16 v[56:59], v[108:111], v[4:7], 0
  ds_read_b128 v[108:111], v244 offset:10240
  v_permlane16_swap_b32 v176, v177
  s_add_u32 m0, s47, 55296
  s_add_u32 s45, s46, 43008
  buffer_load_dwordx4 v250, s[20:23], s45 offen lds
  v_rcp_f32 v177, v177
  s_waitcnt lgkmcnt(3)
  v_mfma_f32_16x16x32_bf16 v[60:63], v[112:115], v[4:7], 0
  ds_read_b128 v[112:115], v244 offset:11264
  v_mul_f32 v176, v13, v177
  v_mul_f32 v177, v13, v177
  v_pk_mul_f32 v[156:157], v[156:157], v[176:177]
  v_pk_mul_f32 v[158:159], v[158:159], v[176:177]
  v_pk_mul_f32 v[160:161], v[160:161], v[176:177]
  v_pk_mul_f32 v[162:163], v[162:163], v[176:177]
  v_cvt_pk_bf16_f32 v180, v156, v157
  v_cvt_pk_bf16_f32 v181, v158, v159
  v_cvt_pk_bf16_f32 v182, v160, v161
  v_cvt_pk_bf16_f32 v183, v162, v163
  v_cmp_lt_u32 vcc, 47, v1
  v_mov_b32 v176, 0
  s_waitcnt lgkmcnt(3)
  v_mfma_f32_16x16x32_bf16 v[64:67], v[100:103], v[4:7], 0
  ds_read_b128 v[100:103], v244 offset:12288
  v_cndmask_b32 v182, v182, v176, vcc
  v_cndmask_b32 v183, v183, v176, vcc
  buffer_store_dwordx4 v[180:183], v248, s[12:15], s60 offen sc1
  s_waitcnt lgkmcnt(3)
  v_mfma_f32_16x16x32_bf16 v[68:71], v[104:107], v[4:7], 0
  ds_read_b128 v[104:107], v244 offset:13312
  s_waitcnt lgkmcnt(3)
  v_mfma_f32_16x16x32_bf16 v[72:75], v[108:111], v[4:7], 0
  ds_read_b128 v[108:111], v244 offset:14336
  s_waitcnt lgkmcnt(3)
  v_mfma_f32_16x16x32_bf16 v[76:79], v[112:115], v[4:7], 0
  ds_read_b128 v[112:115], v244 offset:15360
  s_waitcnt lgkmcnt(3)
  v_mfma_f32_16x16x32_bf16 v[80:83], v[100:103], v[4:7], 0
  ds_read_b128 v[100:103], v245
  s_waitcnt lgkmcnt(3)
  v_mfma_f32_16x16x32_bf16 v[84:87], v[104:107], v[4:7], 0
  s_waitcnt lgkmcnt(2)
  v_mfma_f32_16x16x32_bf16 v[88:91], v[108:111], v[4:7], 0
  s_waitcnt lgkmcnt(1)
  v_mfma_f32_16x16x32_bf16 v[92:95], v[112:115], v[4:7], 0
  s_waitcnt lgkmcnt(0)
  v_mfma_f32_16x16x32_bf16 v[96:99], v[100:103], v[4:7], 0
  ds_read_b128 v[124:127], v246 offset:0
  ds_read_b128 v[128:131], v246 offset:1024
  ds_read_b128 v[132:135], v246 offset:2048
  ds_read_b128 v[136:139], v246 offset:3072
  v_cndmask_b32 v32, v249, v32, s[84:85]
  v_cndmask_b32 v33, v249, v33, s[86:87]
  v_cndmask_b32 v34, v249, v34, s[88:89]
  v_cndmask_b32 v35, v249, v35, s[90:91]
  v_cndmask_b32 v92, v249, v92, s[92:93]
  v_cndmask_b32 v93, v249, v93, s[94:95]
  v_cndmask_b32 v94, v249, v94, s[96:97]
  v_cndmask_b32 v95, v249, v95, s[98:99]
  v_cndmask_b32 v96, v249, v96, s[70:71]
  v_cndmask_b32 v97, v249, v97, s[72:73]
  v_cndmask_b32 v98, v249, v98, s[76:77]
  v_cndmask_b32 v99, v249, v99, s[78:79]
  v_max3_f32 v20, v32, v33, v34
  v_max3_f32 v22, v35, v36, v37
  v_max3_f32 v20, v20, v38, v39
  v_max3_f32 v22, v22, v40, v41
  v_max3_f32 v20, v20, v42, v43
  v_max3_f32 v22, v22, v44, v45
  v_max3_f32 v20, v20, v46, v47
  v_max3_f32 v22, v22, v48, v49
  v_max3_f32 v20, v20, v50, v51
  v_max3_f32 v22, v22, v52, v53
  v_max3_f32 v20, v20, v54, v55
  v_max3_f32 v22, v22, v56, v57
  v_max3_f32 v20, v20, v58, v59
  v_max3_f32 v22, v22, v60, v61
  v_max3_f32 v20, v20, v62, v63
  v_max3_f32 v22, v22, v64, v65
  v_max3_f32 v20, v20, v66, v67
  v_max3_f32 v22, v22, v68, v69
  v_max3_f32 v20, v20, v70, v71
  v_max3_f32 v22, v22, v72, v73
  v_max3_f32 v20, v20, v74, v75
  v_max3_f32 v22, v22, v76, v77
  v_max3_f32 v20, v20, v78, v79
  v_max3_f32 v22, v22, v80, v81
  v_max3_f32 v20, v20, v82, v83
  v_max3_f32 v22, v22, v84, v85
  v_max3_f32 v20, v20, v86, v87
  v_max3_f32 v22, v22, v88, v89
  v_max3_f32 v20, v20, v90, v91
  v_max3_f32 v22, v22, v92, v93
  v_max3_f32 v20, v20, v94, v95
  v_max3_f32 v22, v22, v96, v97
  v_max3_f32 v20, v20, v98, v99
  v_max_f32 v20, v20, v22
  v_mov_b32 v22, v20
  s_nop 1
  v_permlane32_swap_b32 v20, v22
  s_nop 1
  v_max_f32 v20, v20, v22
  v_mov_b32 v22, v20
  s_nop 1
  v_permlane16_swap_b32 v20, v22
  s_nop 1
  v_max_f32 v20, v20, v22
  v_sub_f32 v20, 0, v20
  v_mov_b32 v21, v20
  s_waitcnt vmcnt(0)
  s_barrier
  s_cmp_lg_u32 s34, 0
  s_cbranch_scc1 L_obf_16
  s_add_u32 s4, s0, s49
  s_addc_u32 s5, s1, 0
  s_mov_b32 s6, s36
  s_atomic_swap s6, s[4:5], 0
L_obf_16:
  s_mov_b32 s20, s68
  s_mov_b32 s21, s69
  v_pk_add_f32 v[32:33], v[32:33], v[20:21]
  v_pk_add_f32 v[34:35], v[34:35], v[20:21]
  v_pk_add_f32 v[36:37], v[36:37], v[20:21]
  v_pk_add_f32 v[38:39], v[38:39], v[20:21]
  v_exp_f32 v32, v32
  v_exp_f32 v33, v33
  v_exp_f32 v34, v34
  v_exp_f32 v35, v35
  v_exp_f32 v36, v36
  v_exp_f32 v37, v37
  v_exp_f32 v38, v38
  v_exp_f32 v39, v39
  v_pk_add_f32 v[40:41], v[40:41], v[20:21]
  v_pk_add_f32 v[42:43], v[42:43], v[20:21]
  v_pk_add_f32 v[44:45], v[44:45], v[20:21]
  v_pk_add_f32 v[46:47], v[46:47], v[20:21]
  v_cvt_pk_bf16_f32 v32, v32, v33
  v_cvt_pk_bf16_f32 v33, v34, v35
  v_cvt_pk_bf16_f32 v34, v36, v37
  v_cvt_pk_bf16_f32 v35, v38, v39
  s_add_u32 m0, s47, 106496
  s_add_u32 s45, s46, 0
  buffer_load_dwordx4 v250, s[20:23], s45 offen lds
  s_waitcnt lgkmcnt(2)
  v_mfma_f32_16x16x32_bf16 v[116:119], v[124:127], v[32:35], 0
  v_mfma_f32_16x16x32_bf16 v[120:123], v[128:131], v[32:35], 0
  ds_read_b128 v[124:127], v246 offset:4096
  ds_read_b128 v[128:131], v246 offset:5120
  v_exp_f32 v40, v40
  v_exp_f32 v41, v41
  v_exp_f32 v42, v42
  v_exp_f32 v43, v43
  v_exp_f32 v44, v44
  v_exp_f32 v45, v45
  v_exp_f32 v46, v46
  v_exp_f32 v47, v47
  v_pk_add_f32 v[48:49], v[48:49], v[20:21]
  v_pk_add_f32 v[50:51], v[50:51], v[20:21]
  v_pk_add_f32 v[52:53], v[52:53], v[20:21]
  v_pk_add_f32 v[54:55], v[54:55], v[20:21]
  v_cvt_pk_bf16_f32 v40, v40, v41
  v_cvt_pk_bf16_f32 v41, v42, v43
  v_cvt_pk_bf16_f32 v42, v44, v45
  v_cvt_pk_bf16_f32 v43, v46, v47
  s_add_u32 m0, s47, 107520
  s_add_u32 s45, s46, 7168
  buffer_load_dwordx4 v250, s[20:23], s45 offen lds
  s_waitcnt lgkmcnt(2)
  v_mfma_f32_16x16x32_bf16 v[116:119], v[132:135], v[40:43], v[116:119]
  v_mfma_f32_16x16x32_bf16 v[120:123], v[136:139], v[40:43], v[120:123]
  ds_read_b128 v[132:135], v246 offset:6144
  ds_read_b128 v[136:139], v246 offset:7168
  v_exp_f32 v48, v48
  v_exp_f32 v49, v49
  v_exp_f32 v50, v50
  v_exp_f32 v51, v51
  v_exp_f32 v52, v52
  v_exp_f32 v53, v53
  v_exp_f32 v54, v54
  v_exp_f32 v55, v55
  v_pk_add_f32 v[56:57], v[56:57], v[20:21]
  v_pk_add_f32 v[58:59], v[58:59], v[20:21]
  v_pk_add_f32 v[60:61], v[60:61], v[20:21]
  v_pk_add_f32 v[62:63], v[62:63], v[20:21]
  v_cvt_pk_bf16_f32 v48, v48, v49
  v_cvt_pk_bf16_f32 v49, v50, v51
  v_cvt_pk_bf16_f32 v50, v52, v53
  v_cvt_pk_bf16_f32 v51, v54, v55
  s_add_u32 m0, s47, 108544
  s_add_u32 s45, s46, 14336
  buffer_load_dwordx4 v250, s[20:23], s45 offen lds
  s_waitcnt lgkmcnt(2)
  v_mfma_f32_16x16x32_bf16 v[116:119], v[124:127], v[48:51], v[116:119]
  v_mfma_f32_16x16x32_bf16 v[120:123], v[128:131], v[48:51], v[120:123]
  ds_read_b128 v[124:127], v246 offset:8192
  ds_read_b128 v[128:131], v246 offset:9216
  v_exp_f32 v56, v56
  v_exp_f32 v57, v57
  v_exp_f32 v58, v58
  v_exp_f32 v59, v59
  v_exp_f32 v60, v60
  v_exp_f32 v61, v61
  v_exp_f32 v62, v62
  v_exp_f32 v63, v63
  v_pk_add_f32 v[64:65], v[64:65], v[20:21]
  v_pk_add_f32 v[66:67], v[66:67], v[20:21]
  v_pk_add_f32 v[68:69], v[68:69], v[20:21]
  v_pk_add_f32 v[70:71], v[70:71], v[20:21]
  v_cvt_pk_bf16_f32 v56, v56, v57
  v_cvt_pk_bf16_f32 v57, v58, v59
  v_cvt_pk_bf16_f32 v58, v60, v61
  v_cvt_pk_bf16_f32 v59, v62, v63
  s_add_u32 m0, s47, 109568
  s_add_u32 s45, s46, 21504
  buffer_load_dwordx4 v250, s[20:23], s45 offen lds
  s_waitcnt lgkmcnt(2)
  v_mfma_f32_16x16x32_bf16 v[116:119], v[132:135], v[56:59], v[116:119]
  v_mfma_f32_16x16x32_bf16 v[120:123], v[136:139], v[56:59], v[120:123]
  ds_read_b128 v[132:135], v246 offset:10240
  ds_read_b128 v[136:139], v246 offset:11264
  v_exp_f32 v64, v64
  v_exp_f32 v65, v65
  v_exp_f32 v66, v66
  v_exp_f32 v67, v67
  v_exp_f32 v68, v68
  v_exp_f32 v69, v69
  v_exp_f32 v70, v70
  v_exp_f32 v71, v71
  v_pk_add_f32 v[72:73], v[72:73], v[20:21]
  v_pk_add_f32 v[74:75], v[74:75], v[20:21]
  v_pk_add_f32 v[76:77], v[76:77], v[20:21]
  v_pk_add_f32 v[78:79], v[78:79], v[20:21]
  v_cvt_pk_bf16_f32 v64, v64, v65
  v_cvt_pk_bf16_f32 v65, v66, v67
  v_cvt_pk_bf16_f32 v66, v68, v69
  v_cvt_pk_bf16_f32 v67, v70, v71
  s_add_u32 m0, s47, 110592
  s_add_u32 s45, s46, 28672
  buffer_load_dwordx4 v250, s[20:23], s45 offen lds
  s_waitcnt lgkmcnt(2)
  v_mfma_f32_16x16x32_bf16 v[116:119], v[124:127], v[64:67], v[116:119]
  v_mfma_f32_16x16x32_bf16 v[120:123], v[128:131], v[64:67], v[120:123]
  ds_read_b128 v[124:127], v246 offset:12288
  ds_read_b128 v[128:131], v246 offset:13312
  v_exp_f32 v72, v72
  v_exp_f32 v73, v73
  v_exp_f32 v74, v74
  v_exp_f32 v75, v75
  v_exp_f32 v76, v76
  v_exp_f32 v77, v77
  v_exp_f32 v78, v78
  v_exp_f32 v79, v79
  v_pk_add_f32 v[80:81], v[80:81], v[20:21]
  v_pk_add_f32 v[82:83], v[82:83], v[20:21]
  v_pk_add_f32 v[84:85], v[84:85], v[20:21]
  v_pk_add_f32 v[86:87], v[86:87], v[20:21]
  v_cvt_pk_bf16_f32 v72, v72, v73
  v_cvt_pk_bf16_f32 v73, v74, v75
  v_cvt_pk_bf16_f32 v74, v76, v77
  v_cvt_pk_bf16_f32 v75, v78, v79
  s_add_u32 m0, s47, 111616
  s_add_u32 s45, s46, 35840
  buffer_load_dwordx4 v250, s[20:23], s45 offen lds
  s_waitcnt lgkmcnt(2)
  v_mfma_f32_16x16x32_bf16 v[116:119], v[132:135], v[72:75], v[116:119]
  v_mfma_f32_16x16x32_bf16 v[120:123], v[136:139], v[72:75], v[120:123]
  ds_read_b128 v[132:135], v246 offset:14336
  ds_read_b128 v[136:139], v246 offset:15360
  v_exp_f32 v80, v80
  v_exp_f32 v81, v81
  v_exp_f32 v82, v82
  v_exp_f32 v83, v83
  v_exp_f32 v84, v84
  v_exp_f32 v85, v85
  v_exp_f32 v86, v86
  v_exp_f32 v87, v87
  v_pk_add_f32 v[88:89], v[88:89], v[20:21]
  v_pk_add_f32 v[90:91], v[90:91], v[20:21]
  v_pk_add_f32 v[92:93], v[92:93], v[20:21]
  v_pk_add_f32 v[94:95], v[94:95], v[20:21]
  v_cvt_pk_bf16_f32 v80, v80, v81
  v_cvt_pk_bf16_f32 v81, v82, v83
  v_cvt_pk_bf16_f32 v82, v84, v85
  v_cvt_pk_bf16_f32 v83, v86, v87
  s_add_u32 m0, s47, 112640
  s_add_u32 s45, s46, 43008
  buffer_load_dwordx4 v250, s[20:23], s45 offen lds
  s_waitcnt lgkmcnt(2)
  v_mfma_f32_16x16x32_bf16 v[116:119], v[124:127], v[80:83], v[116:119]
  v_mfma_f32_16x16x32_bf16 v[120:123], v[128:131], v[80:83], v[120:123]
  ds_read_b64 v[124:125], v247 offset:0
  ds_read_b64 v[128:129], v247 offset:1024
  s_cmp_lg_u32 s34, 7
  s_cbranch_scc1 L_obp_17
  s_lshl_b32 s3, s33, 11
  s_add_u32 s80, s3, 0x20000
  s_add_u32 s80, s0, s80
  s_addc_u32 s81, s1, 0
  s_load_dword s24, s[80:81], 0 glc
  s_load_dword s25, s[80:81], 128 glc
  s_load_dword s26, s[80:81], 256 glc
  s_load_dword s27, s[80:81], 384 glc
  s_load_dword s28, s[80:81], 512 glc
  s_load_dword s29, s[80:81], 640 glc
  s_load_dword s30, s[80:81], 768 glc
  s_load_dword s31, s[80:81], 896 glc
  s_load_dword s50, s[80:81], 1024 glc
  s_load_dword s51, s[80:81], 1152 glc
  s_load_dword s52, s[80:81], 1280 glc
  s_load_dword s53, s[80:81], 1408 glc
  s_load_dword s54, s[80:81], 1536 glc
  s_load_dword s55, s[80:81], 1664 glc
  s_load_dword s56, s[80:81], 1792 glc
  s_load_dword s57, s[80:81], 1920 glc
L_obp_17:
  v_exp_f32 v88, v88
  v_exp_f32 v89, v89
  v_exp_f32 v90, v90
  v_exp_f32 v91, v91
  v_exp_f32 v92, v92
  v_exp_f32 v93, v93
  v_exp_f32 v94, v94
  v_exp_f32 v95, v95
  v_pk_add_f32 v[96:97], v[96:97], v[20:21]
  v_pk_add_f32 v[98:99], v[98:99], v[20:21]
  v_cvt_pk_bf16_f32 v88, v88, v89
  v_cvt_pk_bf16_f32 v89, v90, v91
  v_cvt_pk_bf16_f32 v90, v92, v93
  v_cvt_pk_bf16_f32 v91, v94, v95
  s_nop 0
  s_waitcnt lgkmcnt(2)
  v_mfma_f32_16x16x32_bf16 v[116:119], v[132:135], v[88:91], v[116:119]
  v_mfma_f32_16x16x32_bf16 v[120:123], v[136:139], v[88:91], v[120:123]
  v_exp_f32 v96, v96
  v_exp_f32 v97, v97
  v_exp_f32 v98, v98
  v_exp_f32 v99, v99
  s_nop 0
  v_cvt_pk_bf16_f32 v96, v96, v97
  v_cvt_pk_bf16_f32 v97, v98, v99
  s_nop 0
  s_waitcnt lgkmcnt(0)
  v_mfma_f32_16x16x16_bf16 v[116:119], v[124:125], v[96:97], v[116:119]
  v_mfma_f32_16x16x16_bf16 v[120:123], v[128:129], v[96:97], v[120:123]
  s_nop 7
  v_mov_b32 v24, v120
  v_mov_b32 v25, v120
  s_nop 1
  v_permlane32_swap_b32 v24, v25
  s_nop 1
  v_mov_b32 v24, v25
  s_nop 1
  v_permlane16_swap_b32 v24, v25
  s_nop 1
  v_rcp_f32 v25, v25
  s_nop 0
  v_mul_f32 v24, v12, v25
  v_mul_f32 v25, v12, v25
  v_pk_mul_f32 v[116:117], v[116:117], v[24:25]
  v_pk_mul_f32 v[118:119], v[118:119], v[24:25]
  v_pk_mul_f32 v[120:121], v[120:121], v[24:25]
  v_pk_mul_f32 v[122:123], v[122:123], v[24:25]
  v_cvt_pk_bf16_f32 v28, v116, v117
  v_cvt_pk_bf16_f32 v29, v118, v119
  v_cvt_pk_bf16_f32 v30, v120, v121
  v_cvt_pk_bf16_f32 v31, v122, v123
  v_cmp_lt_u32 vcc, 47, v1
  v_mov_b32 v24, 0
  s_nop 0
  v_cndmask_b32 v30, v30, v24, vcc
  v_cndmask_b32 v31, v31, v24, vcc
  s_waitcnt vmcnt(0)
  buffer_store_dwordx4 v[28:31], v248, s[12:15], s61 offen sc1
  s_cmp_lg_u32 s34, 7
  s_cbranch_scc1 L_obc_18
  s_cmp_ge_u32 s32, 14
  s_cbranch_scc1 L_obc_18
  s_waitcnt lgkmcnt(0)
  s_xor_b32 s3, s24, s36
  s_xor_b32 s25, s25, s36
  s_or_b32 s3, s3, s25
  s_xor_b32 s26, s26, s36
  s_or_b32 s3, s3, s26
  s_xor_b32 s27, s27, s36
  s_or_b32 s3, s3, s27
  s_xor_b32 s28, s28, s36
  s_or_b32 s3, s3, s28
  s_xor_b32 s29, s29, s36
  s_or_b32 s3, s3, s29
  s_xor_b32 s30, s30, s36
  s_or_b32 s3, s3, s30
  s_xor_b32 s31, s31, s36
  s_or_b32 s3, s3, s31
  s_xor_b32 s50, s50, s36
  s_or_b32 s3, s3, s50
  s_xor_b32 s51, s51, s36
  s_or_b32 s3, s3, s51
  s_xor_b32 s52, s52, s36
  s_or_b32 s3, s3, s52
  s_xor_b32 s53, s53, s36
  s_or_b32 s3, s3, s53
  s_xor_b32 s54, s54, s36
  s_or_b32 s3, s3, s54
  s_xor_b32 s55, s55, s36
  s_or_b32 s3, s3, s55
  s_xor_b32 s56, s56, s36
  s_or_b32 s3, s3, s56
  s_xor_b32 s57, s57, s36
  s_or_b32 s3, s3, s57
  s_cmp_lg_u32 s3, 0
  s_cbranch_scc0 L_obc_18
  s_mov_b32 s37, 0
L_sp_19:
  s_load_dword s24, s[80:81], 0 glc
  s_load_dword s25, s[80:81], 128 glc
  s_load_dword s26, s[80:81], 256 glc
  s_load_dword s27, s[80:81], 384 glc
  s_load_dword s28, s[80:81], 512 glc
  s_load_dword s29, s[80:81], 640 glc
  s_load_dword s30, s[80:81], 768 glc
  s_load_dword s31, s[80:81], 896 glc
  s_load_dword s50, s[80:81], 1024 glc
  s_load_dword s51, s[80:81], 1152 glc
  s_load_dword s52, s[80:81], 1280 glc
  s_load_dword s53, s[80:81], 1408 glc
  s_load_dword s54, s[80:81], 1536 glc
  s_load_dword s55, s[80:81], 1664 glc
  s_load_dword s56, s[80:81], 1792 glc
  s_load_dword s57, s[80:81], 1920 glc
  s_add_u32 s37, s37, 1
  s_waitcnt lgkmcnt(0)
  s_cmp_gt_u32 s37, 100000
  s_cbranch_scc1 L_spd_20
  s_xor_b32 s3, s24, s36
  s_xor_b32 s25, s25, s36
  s_or_b32 s3, s3, s25
  s_xor_b32 s26, s26, s36
  s_or_b32 s3, s3, s26
  s_xor_b32 s27, s27, s36
  s_or_b32 s3, s3, s27
  s_xor_b32 s28, s28, s36
  s_or_b32 s3, s3, s28
  s_xor_b32 s29, s29, s36
  s_or_b32 s3, s3, s29
  s_xor_b32 s30, s30, s36
  s_or_b32 s3, s3, s30
  s_xor_b32 s31, s31, s36
  s_or_b32 s3, s3, s31
  s_xor_b32 s50, s50, s36
  s_or_b32 s3, s3, s50
  s_xor_b32 s51, s51, s36
  s_or_b32 s3, s3, s51
  s_xor_b32 s52, s52, s36
  s_or_b32 s3, s3, s52
  s_xor_b32 s53, s53, s36
  s_or_b32 s3, s3, s53
  s_xor_b32 s54, s54, s36
  s_or_b32 s3, s3, s54
  s_xor_b32 s55, s55, s36
  s_or_b32 s3, s3, s55
  s_xor_b32 s56, s56, s36
  s_or_b32 s3, s3, s56
  s_xor_b32 s57, s57, s36
  s_or_b32 s3, s3, s57
  s_cmp_lg_u32 s3, 0
  s_cbranch_scc1 L_sp_19
L_spd_20:
L_obc_18:
  s_setprio 0
  s_barrier
  s_cmp_ge_u32 s32, 14
  s_cbranch_scc1 L_noop_21
  s_add_u32 s44, s101, 0
  s_and_b32 s44, s44, 3
  s_add_u32 s45, s101, 1
  s_and_b32 s45, s45, 3
  s_add_u32 s46, s101, 2
  s_and_b32 s46, s46, 3
  s_add_u32 s47, s101, 3
  s_and_b32 s47, s47, 3
  s_lshl_b32 s38, s33, 3
  s_lshl_b32 s39, s100, 2
  s_add_u32 s38, s38, s39
  s_lshr_b32 s39, s34, 1
  s_add_u32 s38, s38, s39
  s_lshl_b32 s38, s38, 14
  s_and_b32 s42, s34, 1
  s_lshl_b32 s42, s42, 11
  s_add_u32 s38, s38, s42
  s_add_u32 s40, s38, 0xa00000
  s_lshl_b32 s41, s39, 12
  s_add_u32 s41, s41, s42
  s_lshl_b32 s43, s44, 12
  s_add_u32 m0, s41, 0
  s_add_u32 s43, s43, s40
  buffer_load_dwordx4 v248, s[12:15], s43 offen sc1 lds
  buffer_load_dwordx4 v248, s[12:15], s43 offen offset:1024 sc1 lds
  s_lshl_b32 s43, s45, 12
  s_add_u32 m0, s41, 16384
  s_add_u32 s43, s43, s40
  buffer_load_dwordx4 v248, s[12:15], s43 offen sc1 lds
  buffer_load_dwordx4 v248, s[12:15], s43 offen offset:1024 sc1 lds
  s_lshl_b32 s43, s46, 12
  s_add_u32 m0, s41, 32768
  s_add_u32 s43, s43, s40
  buffer_load_dwordx4 v248, s[12:15], s43 offen sc1 lds
  buffer_load_dwordx4 v248, s[12:15], s43 offen offset:1024 sc1 lds
  v_lshrrev_b32 v5, 5, v1
  v_lshlrev_b32 v5, 2, v5
  v_bfe_u32 v6, v1, 2, 2
  v_add_u32 v5, v5, v6
  v_lshlrev_b32 v5, 7, v5
  s_and_b32 s38, s34, 1
  s_lshl_b32 s38, s38, 3
  v_bfe_u32 v7, v1, 4, 1
  v_lshlrev_b32 v7, 2, v7
  v_and_b32 v8, 3, v1
  v_add_u32 v7, v7, v8
  v_add_u32 v7, s38, v7
  v_lshrrev_b32 v6, 1, v6
  v_lshlrev_b32 v6, 3, v6
  v_xor_b32 v7, v7, v6
  v_lshl_add_u32 v5, v7, 3, v5
  s_mov_b32 s37, 49152
  s_cmp_lt_u32 s34, 4
  s_cselect_b32 s37, 106496, s37
  s_mul_i32 s38, s44, 14336
  s_add_u32 s39, s38, s37
  v_add_u32 v192, s39, v5
  s_mul_i32 s38, s45, 14336
  s_add_u32 s39, s38, s37
  v_add_u32 v193, s39, v5
  s_mul_i32 s38, s46, 14336
  s_add_u32 s39, s38, s37
  v_add_u32 v194, s39, v5
  s_mul_i32 s38, s47, 14336
  s_add_u32 s39, s38, s37
  v_add_u32 v195, s39, v5
  ds_read_b64_tr_b16 v[64:65], v192 offset:0
  ds_read_b64_tr_b16 v[66:67], v192 offset:2048
  ds_read_b64_tr_b16 v[68:69], v192 offset:1024
  ds_read_b64_tr_b16 v[70:71], v192 offset:3072
  ds_read_b64_tr_b16 v[72:73], v192 offset:3584
  ds_read_b64_tr_b16 v[74:75], v192 offset:5632
  ds_read_b64_tr_b16 v[76:77], v192 offset:4608
  ds_read_b64_tr_b16 v[78:79], v192 offset:6656
  ds_read_b64_tr_b16 v[80:81], v192 offset:7168
  ds_read_b64_tr_b16 v[82:83], v192 offset:9216
  ds_read_b64_tr_b16 v[84:85], v192 offset:8192
  ds_read_b64_tr_b16 v[86:87], v192 offset:10240
  ds_read_b64_tr_b16 v[88:89], v192 offset:10752
  ds_read_b64_tr_b16 v[90:91], v192 offset:12800
  ds_read_b64_tr_b16 v[92:93], v192 offset:11776
  ds_read_b64_tr_b16 v[94:95], v192 offset:13824
  ds_read_b64_tr_b16 v[96:97], v193 offset:0
  ds_read_b64_tr_b16 v[98:99], v193 offset:2048
  ds_read_b64_tr_b16 v[100:101], v193 offset:1024
  ds_read_b64_tr_b16 v[102:103], v193 offset:3072
  ds_read_b64_tr_b16 v[104:105], v193 offset:3584
  ds_read_b64_tr_b16 v[106:107], v193 offset:5632
  ds_read_b64_tr_b16 v[108:109], v193 offset:4608
  ds_read_b64_tr_b16 v[110:111], v193 offset:6656
  ds_read_b64_tr_b16 v[112:113], v193 offset:7168
  ds_read_b64_tr_b16 v[114:115], v193 offset:9216
  ds_read_b64_tr_b16 v[116:117], v193 offset:8192
  ds_read_b64_tr_b16 v[118:119], v193 offset:10240
  ds_read_b64_tr_b16 v[120:121], v193 offset:10752
  ds_read_b64_tr_b16 v[122:123], v193 offset:12800
  ds_read_b64_tr_b16 v[124:125], v193 offset:11776
  ds_read_b64_tr_b16 v[126:127], v193 offset:13824
  s_waitcnt vmcnt(6)
  s_barrier
  s_cmp_lg_u32 s34, 7
  s_cbranch_scc1 L_oaf_22
  s_add_u32 s4, s0, s59
  s_addc_u32 s5, s1, 0
  s_mov_b32 s6, s36
  s_atomic_swap s6, s[4:5], 0
L_oaf_22:
  ds_read_b64_tr_b16 v[128:129], v194 offset:0
  ds_read_b64_tr_b16 v[130:131], v194 offset:2048
  ds_read_b64_tr_b16 v[132:133], v194 offset:1024
  ds_read_b64_tr_b16 v[134:135], v194 offset:3072
  ds_read_b64_tr_b16 v[136:137], v194 offset:3584
  ds_read_b64_tr_b16 v[138:139], v194 offset:5632
  ds_read_b64_tr_b16 v[140:141], v194 offset:4608
  ds_read_b64_tr_b16 v[142:143], v194 offset:6656
  ds_read_b64_tr_b16 v[144:145], v194 offset:7168
  ds_read_b64_tr_b16 v[146:147], v194 offset:9216
  ds_read_b64_tr_b16 v[148:149], v194 offset:8192
  ds_read_b64_tr_b16 v[150:151], v194 offset:10240
  ds_read_b64_tr_b16 v[152:153], v194 offset:10752
  ds_read_b64_tr_b16 v[154:155], v194 offset:12800
  ds_read_b64_tr_b16 v[156:157], v194 offset:11776
  ds_read_b64_tr_b16 v[158:159], v194 offset:13824
  ds_read_b64_tr_b16 v[160:161], v195 offset:0
  ds_read_b64_tr_b16 v[162:163], v195 offset:2048
  ds_read_b64_tr_b16 v[164:165], v195 offset:1024
  ds_read_b64_tr_b16 v[166:167], v195 offset:3072
  ds_read_b64_tr_b16 v[168:169], v195 offset:3584
  ds_read_b64_tr_b16 v[170:171], v195 offset:5632
  ds_read_b64_tr_b16 v[172:173], v195 offset:4608
  ds_read_b64_tr_b16 v[174:175], v195 offset:6656
  ds_read_b64_tr_b16 v[176:177], v195 offset:7168
  ds_read_b64_tr_b16 v[178:179], v195 offset:9216
  ds_read_b64_tr_b16 v[180:181], v195 offset:8192
  ds_read_b64_tr_b16 v[182:183], v195 offset:10240
  ds_read_b64_tr_b16 v[184:185], v195 offset:10752
  ds_read_b64_tr_b16 v[186:187], v195 offset:12800
  ds_read_b64_tr_b16 v[188:189], v195 offset:11776
  ds_read_b64_tr_b16 v[190:191], v195 offset:13824
  s_lshr_b32 s38, s35, 1
  s_lshl_b32 s38, s38, 1
  v_bfe_u32 v8, v1, 4, 1
  v_add_u32 v8, s38, v8
  v_lshlrev_b32 v9, 12, v8
  v_lshrrev_b32 v10, 5, v1
  v_lshl_add_u32 v9, v10, 8, v9
  v_and_b32 v10, 15, v1
  v_lshl_add_u32 v9, v10, 4, v9
  s_lshl_b32 s38, s35, 12
  s_add_u32 s38, s38, 139264
  v_add_u32 v11, s38, v248
  s_waitcnt lgkmcnt(0)
  s_barrier
  s_lshl_b32 s43, s47, 12
  s_add_u32 m0, s41, 49152
  s_add_u32 s43, s43, s40
  buffer_load_dwordx4 v248, s[12:15], s43 offen sc1 lds
  buffer_load_dwordx4 v248, s[12:15], s43 offen offset:1024 sc1 lds
  s_cmp_ge_u32 s34, 4
  s_cbranch_scc1 L_opB_23
  s_lshr_b32 s38, s34, 1
  s_lshl_b32 s38, s38, 5
  v_and_b32 v3, 31, v1
  v_add_u32 v3, s38, v3
  v_and_b32 v12, 7, v3
  v_lshrrev_b32 v10, 5, v1
  v_lshlrev_b32 v10, 3, v10
  v_lshl_add_u32 v10, v3, 7, v10
  v_add_u32 v10, 155648, v10
  s_and_b32 s38, s34, 1
  s_lshl_b32 s38, s38, 2
  s_add_u32 s39, s38, 0
  v_xor_b32 v4, s39, v12
  v_lshl_add_u32 v4, v4, 4, v10
  s_add_u32 s39, s38, 1
  v_xor_b32 v5, s39, v12
  v_lshl_add_u32 v5, v5, 4, v10
  s_add_u32 s39, s38, 2
  v_xor_b32 v6, s39, v12
  v_lshl_add_u32 v6, v6, 4, v10
  s_add_u32 s39, s38, 3
  v_xor_b32 v7, s39, v12
  v_lshl_add_u32 v7, v7, 4, v10
  s_lshl_b32 s38, s34, 4
  v_lshrrev_b32 v3, 3, v1
  v_add_u32 v3, s38, v3
  v_and_b32 v10, 7, v1
  v_lshlrev_b32 v13, 4, v10
  v_lshl_add_u32 v13, v3, 7, v13
  v_add_u32 v13, 155648, v13
  v_and_b32 v14, 7, v3
  v_xor_b32 v10, v10, v14
  v_lshlrev_b32 v10, 4, v10
  s_mov_b32 s39, 896
  v_mul_lo_u32 v14, v3, s39
  v_add_u32 v14, v14, v10
  s_lshl_b32 s38, s33, 7
  s_lshl_b32 s39, s100, 6
  s_add_u32 s38, s38, s39
  s_mul_i32 s38, s38, 896
  s_lshl_b32 s39, s101, 7
  s_add_u32 s48, s38, s39
  s_add_u32 s49, s48, 7168
  v_add_u32 v15, 65536, v9
  v_add_u32 v12, 106496, v9
  s_lshl_b32 s38, s33, 3
  s_lshl_b32 s39, s100, 2
  s_add_u32 s38, s38, s39
  s_add_u32 s38, s38, s34
  s_lshl_b32 s38, s38, 14
  s_add_u32 s40, s38, 0x800000
  s_lshl_b32 s41, s34, 12
  s_lshl_b32 s3, s33, 11
  s_add_u32 s80, s3, 0x28000
  s_add_u32 s80, s0, s80
  s_addc_u32 s81, s1, 0
  s_waitcnt vmcnt(0)
  s_barrier
  s_cmp_lg_u32 s34, 0
  s_cbranch_scc1 L_oap_24
  s_mov_b32 s37, 0
L_sp_25:
  s_load_dword s84, s[80:81], 0 glc
  s_load_dword s85, s[80:81], 128 glc
  s_load_dword s86, s[80:81], 256 glc
  s_load_dword s87, s[80:81], 384 glc
  s_load_dword s88, s[80:81], 512 glc
  s_load_dword s89, s[80:81], 640 glc
  s_load_dword s90, s[80:81], 768 glc
  s_load_dword s91, s[80:81], 896 glc
  s_load_dword s92, s[80:81], 1024 glc
  s_load_dword s93, s[80:81], 1152 glc
  s_load_dword s94, s[80:81], 1280 glc
  s_load_dword s95, s[80:81], 1408 glc
  s_load_dword s96, s[80:81], 1536 glc
  s_load_dword s97, s[80:81], 1664 glc
  s_load_dword s98, s[80:81], 1792 glc
  s_load_dword s99, s[80:81], 1920 glc
  s_add_u32 s37, s37, 1
  s_waitcnt lgkmcnt(0)
  s_cmp_gt_u32 s37, 100000
  s_cbranch_scc1 L_spd_26
  s_xor_b32 s3, s84, s36
  s_xor_b32 s85, s85, s36
  s_or_b32 s3, s3, s85
  s_xor_b32 s86, s86, s36
  s_or_b32 s3, s3, s86
  s_xor_b32 s87, s87, s36
  s_or_b32 s3, s3, s87
  s_xor_b32 s88, s88, s36
  s_or_b32 s3, s3, s88
  s_xor_b32 s89, s89, s36
  s_or_b32 s3, s3, s89
  s_xor_b32 s90, s90, s36
  s_or_b32 s3, s3, s90
  s_xor_b32 s91, s91, s36
  s_or_b32 s3, s3, s91
  s_xor_b32 s92, s92, s36
  s_or_b32 s3, s3, s92
  s_xor_b32 s93, s93, s36
  s_or_b32 s3, s3, s93
  s_xor_b32 s94, s94, s36
  s_or_b32 s3, s3, s94
  s_xor_b32 s95, s95, s36
  s_or_b32 s3, s3, s95
  s_xor_b32 s96, s96, s36
  s_or_b32 s3, s3, s96
  s_xor_b32 s97, s97, s36
  s_or_b32 s3, s3, s97
  s_xor_b32 s98, s98, s36
  s_or_b32 s3, s3, s98
  s_xor_b32 s99, s99, s36
  s_or_b32 s3, s3, s99
  s_cmp_lg_u32 s3, 0
  s_cbranch_scc1 L_sp_25
L_spd_26:
L_oap_24:
  s_barrier
  s_lshl_b32 s43, s44, 12
  s_add_u32 m0, s41, 65536
  s_add_u32 s43, s43, s40
  buffer_load_dwordx4 v248, s[12:15], s43 offen offset:0 sc1 lds
  buffer_load_dwordx4 v248, s[12:15], s43 offen offset:1024 sc1 lds
  buffer_load_dwordx4 v248, s[12:15], s43 offen offset:2048 sc1 lds
  buffer_load_dwordx4 v248, s[12:15], s43 offen offset:3072 sc1 lds
  s_lshl_b32 s43, s45, 12
  s_add_u32 m0, s41, 81920
  s_add_u32 s43, s43, s40
  buffer_load_dwordx4 v248, s[12:15], s43 offen offset:0 sc1 lds
  buffer_load_dwordx4 v248, s[12:15], s43 offen offset:1024 sc1 lds
  buffer_load_dwordx4 v248, s[12:15], s43 offen offset:2048 sc1 lds
  buffer_load_dwordx4 v248, s[12:15], s43 offen offset:3072 sc1 lds
  s_lshl_b32 s43, s46, 12
  s_add_u32 m0, s41, 106496
  s_add_u32 s43, s43, s40
  buffer_load_dwordx4 v248, s[12:15], s43 offen offset:0 sc1 lds
  buffer_load_dwordx4 v248, s[12:15], s43 offen offset:1024 sc1 lds
  buffer_load_dwordx4 v248, s[12:15], s43 offen offset:2048 sc1 lds
  buffer_load_dwordx4 v248, s[12:15], s43 offen offset:3072 sc1 lds
  s_lshl_b32 s43, s47, 12
  s_add_u32 m0, s41, 122880
  s_add_u32 s43, s43, s40
  buffer_load_dwordx4 v248, s[12:15], s43 offen offset:0 sc1 lds
  buffer_load_dwordx4 v248, s[12:15], s43 offen offset:1024 sc1 lds
  buffer_load_dwordx4 v248, s[12:15], s43 offen offset:2048 sc1 lds
  buffer_load_dwordx4 v248, s[12:15], s43 offen offset:3072 sc1 lds
  s_waitcnt vmcnt(12)
  s_barrier
  ds_read_b128 v[16:19], v11 offset:0
  ds_read_b128 v[20:23], v11 offset:1024
  ds_read_b128 v[24:27], v11 offset:2048
  ds_read_b128 v[28:31], v11 offset:3072
  ds_read_b128 v[32:35], v15 offset:0
  ds_read_b128 v[36:39], v15 offset:512
  ds_read_b128 v[40:43], v15 offset:1024
  ds_read_b128 v[44:47], v15 offset:1536
  ds_read_b128 v[48:51], v15 offset:2048
  ds_read_b128 v[52:55], v15 offset:2560
  ds_read_b128 v[56:59], v15 offset:3072
  ds_read_b128 v[60:63], v15 offset:3584
  s_waitcnt vmcnt(8)
  s_barrier
  ds_read_b128 v[200:203], v15 offset:16384
  ds_read_b128 v[204:207], v15 offset:16896
  ds_read_b128 v[208:211], v15 offset:17408
  ds_read_b128 v[212:215], v15 offset:17920
  ds_read_b128 v[216:219], v15 offset:18432
  ds_read_b128 v[220:223], v15 offset:18944
  ds_read_b128 v[224:227], v15 offset:19456
  ds_read_b128 v[228:231], v15 offset:19968
  s_waitcnt lgkmcnt(15)
  v_mfma_f32_32x32x16_bf16 v[16:31], v[64:67], v[32:35], v[16:31]
  s_waitcnt lgkmcnt(14)
  v_mfma_f32_32x32x16_bf16 v[16:31], v[68:71], v[36:39], v[16:31]
  s_waitcnt lgkmcnt(13)
  v_mfma_f32_32x32x16_bf16 v[16:31], v[72:75], v[40:43], v[16:31]
  s_waitcnt lgkmcnt(12)
  v_mfma_f32_32x32x16_bf16 v[16:31], v[76:79], v[44:47], v[16:31]
  s_waitcnt lgkmcnt(11)
  v_mfma_f32_32x32x16_bf16 v[16:31], v[80:83], v[48:51], v[16:31]
  s_waitcnt lgkmcnt(10)
  v_mfma_f32_32x32x16_bf16 v[16:31], v[84:87], v[52:55], v[16:31]
  s_waitcnt lgkmcnt(9)
  v_mfma_f32_32x32x16_bf16 v[16:31], v[88:91], v[56:59], v[16:31]
  s_waitcnt lgkmcnt(8)
  v_mfma_f32_32x32x16_bf16 v[16:31], v[92:95], v[60:63], v[16:31]
  s_waitcnt vmcnt(4)
  s_barrier
  ds_read_b128 v[32:35], v12 offset:0
  ds_read_b128 v[36:39], v12 offset:512
  ds_read_b128 v[40:43], v12 offset:1024
  ds_read_b128 v[44:47], v12 offset:1536
  ds_read_b128 v[48:51], v12 offset:2048
  ds_read_b128 v[52:55], v12 offset:2560
  ds_read_b128 v[56:59], v12 offset:3072
  ds_read_b128 v[60:63], v12 offset:3584
  s_waitcnt lgkmcnt(15)
  v_mfma_f32_32x32x16_bf16 v[16:31], v[96:99], v[200:203], v[16:31]
  s_waitcnt lgkmcnt(14)
  v_mfma_f32_32x32x16_bf16 v[16:31], v[100:103], v[204:207], v[16:31]
  s_waitcnt lgkmcnt(13)
  v_mfma_f32_32x32x16_bf16 v[16:31], v[104:107], v[208:211], v[16:31]
  s_waitcnt lgkmcnt(12)
  v_mfma_f32_32x32x16_bf16 v[16:31], v[108:111], v[212:215], v[16:31]
  s_waitcnt lgkmcnt(11)
  v_mfma_f32_32x32x16_bf16 v[16:31], v[112:115], v[216:219], v[16:31]
  s_waitcnt lgkmcnt(10)
  v_mfma_f32_32x32x16_bf16 v[16:31], v[116:119], v[220:223], v[16:31]
  s_waitcnt lgkmcnt(9)
  v_mfma_f32_32x32x16_bf16 v[16:31], v[120:123], v[224:227], v[16:31]
  s_waitcnt lgkmcnt(8)
  v_mfma_f32_32x32x16_bf16 v[16:31], v[124:127], v[228:231], v[16:31]
  s_waitcnt vmcnt(0)
  s_barrier
  ds_read_b128 v[200:203], v12 offset:16384
  ds_read_b128 v[204:207], v12 offset:16896
  ds_read_b128 v[208:211], v12 offset:17408
  ds_read_b128 v[212:215], v12 offset:17920
  ds_read_b128 v[216:219], v12 offset:18432
  ds_read_b128 v[220:223], v12 offset:18944
  ds_read_b128 v[224:227], v12 offset:19456
  ds_read_b128 v[228:231], v12 offset:19968
  s_waitcnt lgkmcnt(15)
  v_mfma_f32_32x32x16_bf16 v[16:31], v[128:131], v[32:35], v[16:31]
  s_waitcnt lgkmcnt(14)
  v_mfma_f32_32x32x16_bf16 v[16:31], v[132:135], v[36:39], v[16:31]
  s_waitcnt lgkmcnt(13)
  v_mfma_f32_32x32x16_bf16 v[16:31], v[136:139], v[40:43], v[16:31]
  s_waitcnt lgkmcnt(12)
  v_mfma_f32_32x32x16_bf16 v[16:31], v[140:143], v[44:47], v[16:31]
  s_waitcnt lgkmcnt(11)
  v_mfma_f32_32x32x16_bf16 v[16:31], v[144:147], v[48:51], v[16:31]
  s_waitcnt lgkmcnt(10)
  v_mfma_f32_32x32x16_bf16 v[16:31], v[148:151], v[52:55], v[16:31]
  s_waitcnt lgkmcnt(9)
  v_mfma_f32_32x32x16_bf16 v[16:31], v[152:155], v[56:59], v[16:31]
  s_waitcnt lgkmcnt(8)
  v_mfma_f32_32x32x16_bf16 v[16:31], v[156:159], v[60:63], v[16:31]
  s_waitcnt lgkmcnt(7)
  v_mfma_f32_32x32x16_bf16 v[16:31], v[160:163], v[200:203], v[16:31]
  s_waitcnt lgkmcnt(6)
  v_mfma_f32_32x32x16_bf16 v[16:31], v[164:167], v[204:207], v[16:31]
  s_waitcnt lgkmcnt(5)
  v_mfma_f32_32x32x16_bf16 v[16:31], v[168:171], v[208:211], v[16:31]
  s_waitcnt lgkmcnt(4)
  v_mfma_f32_32x32x16_bf16 v[16:31], v[172:175], v[212:215], v[16:31]
  s_waitcnt lgkmcnt(3)
  v_mfma_f32_32x32x16_bf16 v[16:31], v[176:179], v[216:219], v[16:31]
  s_waitcnt lgkmcnt(2)
  v_mfma_f32_32x32x16_bf16 v[16:31], v[180:183], v[220:223], v[16:31]
  s_waitcnt lgkmcnt(1)
  v_mfma_f32_32x32x16_bf16 v[16:31], v[184:187], v[224:227], v[16:31]
  s_waitcnt lgkmcnt(0)
  v_mfma_f32_32x32x16_bf16 v[16:31], v[188:191], v[228:231], v[16:31]
  s_nop 11
  v_cvt_pk_bf16_f32 v32, v16, v17
  v_cvt_pk_bf16_f32 v33, v18, v19
  v_cvt_pk_bf16_f32 v34, v20, v21
  v_cvt_pk_bf16_f32 v35, v22, v23
  v_cvt_pk_bf16_f32 v36, v24, v25
  v_cvt_pk_bf16_f32 v37, v26, v27
  v_cvt_pk_bf16_f32 v38, v28, v29
  v_cvt_pk_bf16_f32 v39, v30, v31
  ds_write_b64 v4, v[32:33]
  ds_write_b64 v5, v[34:35]
  ds_write_b64 v6, v[36:37]
  ds_write_b64 v7, v[38:39]
  s_waitcnt lgkmcnt(0)
  s_barrier
  ds_read_b128 v[32:35], v13
  ds_read_b128 v[36:39], v13 offset:1024
  s_waitcnt lgkmcnt(1)
  buffer_store_dwordx4 v[32:35], v14, s[16:19], s48 offen sc1
  s_waitcnt lgkmcnt(0)
  buffer_store_dwordx4 v[36:39], v14, s[16:19], s49 offen sc1
  s_branch L_fin
L_opB_23:
  v_add_u32 v12, 49152, v9
  s_waitcnt vmcnt(0)
  s_barrier
  ds_read_b128 v[32:35], v9 offset:0
  ds_read_b128 v[36:39], v9 offset:512
  ds_read_b128 v[40:43], v9 offset:1024
  ds_read_b128 v[44:47], v9 offset:1536
  ds_read_b128 v[48:51], v9 offset:2048
  ds_read_b128 v[52:55], v9 offset:2560
  ds_read_b128 v[56:59], v9 offset:3072
  ds_read_b128 v[60:63], v9 offset:3584
  ds_read_b128 v[200:203], v9 offset:16384
  ds_read_b128 v[204:207], v9 offset:16896
  ds_read_b128 v[208:211], v9 offset:17408
  ds_read_b128 v[212:215], v9 offset:17920
  ds_read_b128 v[216:219], v9 offset:18432
  ds_read_b128 v[220:223], v9 offset:18944
  ds_read_b128 v[224:227], v9 offset:19456
  ds_read_b128 v[228:231], v9 offset:19968
  s_waitcnt lgkmcnt(15)
  v_mfma_f32_32x32x16_bf16 v[16:31], v[64:67], v[32:35], 0
  s_waitcnt lgkmcnt(14)
  v_mfma_f32_32x32x16_bf16 v[16:31], v[68:71], v[36:39], v[16:31]
  s_waitcnt lgkmcnt(13)
  v_mfma_f32_32x32x16_bf16 v[16:31], v[72:75], v[40:43], v[16:31]
  s_waitcnt lgkmcnt(12)
  v_mfma_f32_32x32x16_bf16 v[16:31], v[76:79], v[44:47], v[16:31]
  s_waitcnt lgkmcnt(11)
  v_mfma_f32_32x32x16_bf16 v[16:31], v[80:83], v[48:51], v[16:31]
  s_waitcnt lgkmcnt(10)
  v_mfma_f32_32x32x16_bf16 v[16:31], v[84:87], v[52:55], v[16:31]
  s_waitcnt lgkmcnt(9)
  v_mfma_f32_32x32x16_bf16 v[16:31], v[88:91], v[56:59], v[16:31]
  s_waitcnt lgkmcnt(8)
  v_mfma_f32_32x32x16_bf16 v[16:31], v[92:95], v[60:63], v[16:31]
  ds_read_b128 v[32:35], v9 offset:32768
  ds_read_b128 v[36:39], v9 offset:33280
  ds_read_b128 v[40:43], v9 offset:33792
  ds_read_b128 v[44:47], v9 offset:34304
  ds_read_b128 v[48:51], v9 offset:34816
  ds_read_b128 v[52:55], v9 offset:35328
  ds_read_b128 v[56:59], v9 offset:35840
  ds_read_b128 v[60:63], v9 offset:36352
  s_waitcnt lgkmcnt(15)
  v_mfma_f32_32x32x16_bf16 v[16:31], v[96:99], v[200:203], v[16:31]
  s_waitcnt lgkmcnt(14)
  v_mfma_f32_32x32x16_bf16 v[16:31], v[100:103], v[204:207], v[16:31]
  s_waitcnt lgkmcnt(13)
  v_mfma_f32_32x32x16_bf16 v[16:31], v[104:107], v[208:211], v[16:31]
  s_waitcnt lgkmcnt(12)
  v_mfma_f32_32x32x16_bf16 v[16:31], v[108:111], v[212:215], v[16:31]
  s_waitcnt lgkmcnt(11)
  v_mfma_f32_32x32x16_bf16 v[16:31], v[112:115], v[216:219], v[16:31]
  s_waitcnt lgkmcnt(10)
  v_mfma_f32_32x32x16_bf16 v[16:31], v[116:119], v[220:223], v[16:31]
  s_waitcnt lgkmcnt(9)
  v_mfma_f32_32x32x16_bf16 v[16:31], v[120:123], v[224:227], v[16:31]
  s_waitcnt lgkmcnt(8)
  v_mfma_f32_32x32x16_bf16 v[16:31], v[124:127], v[228:231], v[16:31]
  ds_read_b128 v[200:203], v12 offset:0
  ds_read_b128 v[204:207], v12 offset:512
  ds_read_b128 v[208:211], v12 offset:1024
  ds_read_b128 v[212:215], v12 offset:1536
  ds_read_b128 v[216:219], v12 offset:2048
  ds_read_b128 v[220:223], v12 offset:2560
  ds_read_b128 v[224:227], v12 offset:3072
  ds_read_b128 v[228:231], v12 offset:3584
  s_waitcnt lgkmcnt(15)
  v_mfma_f32_32x32x16_bf16 v[16:31], v[128:131], v[32:35], v[16:31]
  s_waitcnt lgkmcnt(14)
  v_mfma_f32_32x32x16_bf16 v[16:31], v[132:135], v[36:39], v[16:31]
  s_waitcnt lgkmcnt(13)
  v_mfma_f32_32x32x16_bf16 v[16:31], v[136:139], v[40:43], v[16:31]
  s_waitcnt lgkmcnt(12)
  v_mfma_f32_32x32x16_bf16 v[16:31], v[140:143], v[44:47], v[16:31]
  s_waitcnt lgkmcnt(11)
  v_mfma_f32_32x32x16_bf16 v[16:31], v[144:147], v[48:51], v[16:31]
  s_waitcnt lgkmcnt(10)
  v_mfma_f32_32x32x16_bf16 v[16:31], v[148:151], v[52:55], v[16:31]
  s_waitcnt lgkmcnt(9)
  v_mfma_f32_32x32x16_bf16 v[16:31], v[152:155], v[56:59], v[16:31]
  s_waitcnt lgkmcnt(8)
  v_mfma_f32_32x32x16_bf16 v[16:31], v[156:159], v[60:63], v[16:31]
  s_waitcnt lgkmcnt(7)
  v_mfma_f32_32x32x16_bf16 v[16:31], v[160:163], v[200:203], v[16:31]
  s_waitcnt lgkmcnt(6)
  v_mfma_f32_32x32x16_bf16 v[16:31], v[164:167], v[204:207], v[16:31]
  s_waitcnt lgkmcnt(5)
  v_mfma_f32_32x32x16_bf16 v[16:31], v[168:171], v[208:211], v[16:31]
  s_waitcnt lgkmcnt(4)
  v_mfma_f32_32x32x16_bf16 v[16:31], v[172:175], v[212:215], v[16:31]
  s_waitcnt lgkmcnt(3)
  v_mfma_f32_32x32x16_bf16 v[16:31], v[176:179], v[216:219], v[16:31]
  s_waitcnt lgkmcnt(2)
  v_mfma_f32_32x32x16_bf16 v[16:31], v[180:183], v[220:223], v[16:31]
  s_waitcnt lgkmcnt(1)
  v_mfma_f32_32x32x16_bf16 v[16:31], v[184:187], v[224:227], v[16:31]
  s_waitcnt lgkmcnt(0)
  v_mfma_f32_32x32x16_bf16 v[16:31], v[188:191], v[228:231], v[16:31]
  s_nop 11
  ds_write_b128 v11, v[16:19] offset:0
  ds_write_b128 v11, v[20:23] offset:1024
  ds_write_b128 v11, v[24:27] offset:2048
  ds_write_b128 v11, v[28:31] offset:3072
  s_waitcnt lgkmcnt(0)
  s_barrier
  s_barrier
  s_barrier
  s_barrier
  s_barrier
  s_barrier
  s_branch L_fin
L_noop_21:
  s_waitcnt vmcnt(0)
  s_barrier
  s_cmp_lg_u32 s34, 5
  s_cbranch_scc1 L_nu_27
  s_cmp_lg_u32 s48, 15
  s_cbranch_scc1 L_nu_27
  v_lshlrev_b32 v24, 7, v1
  v_add_u32 v24, 98304, v24
  s_mov_b32 s38, 0
L_nul_28:
  s_mov_b32 s39, 0
  buffer_load_dword v25, v24, s[12:15], s39 offen sc1
  s_mov_b32 s39, 8192
  buffer_load_dword v26, v24, s[12:15], s39 offen sc1
  s_mov_b32 s39, 16384
  buffer_load_dword v27, v24, s[12:15], s39 offen sc1
  s_mov_b32 s39, 24576
  buffer_load_dword v28, v24, s[12:15], s39 offen sc1
  s_add_u32 s38, s38, 1
  s_waitcnt vmcnt(0)
  s_mov_b64 s[42:43], 0
  v_cmp_ne_u32 vcc, s36, v25
  s_nop 1
  s_or_b64 s[42:43], s[42:43], vcc
  v_cmp_ne_u32 vcc, s36, v26
  s_nop 1
  s_or_b64 s[42:43], s[42:43], vcc
  v_cmp_ne_u32 vcc, s36, v27
  s_nop 1
  s_or_b64 s[42:43], s[42:43], vcc
  v_cmp_ne_u32 vcc, s36, v28
  s_nop 1
  s_or_b64 s[42:43], s[42:43], vcc
  s_cmp_gt_u32 s38, 30000
  s_cbranch_scc1 L_nud_29
  s_cmp_lg_u64 s[42:43], 0
  s_cbranch_scc1 L_nul_28
L_nud_29:
  v_mov_b32 v30, 0
  v_mov_b32 v29, s36
  s_mov_b64 exec, 1
  buffer_store_dword v29, v30, s[12:15], 0 offen sc1
  s_mov_b64 exec, -1
L_nu_27:
  s_cmp_lg_u32 s34, 7
  s_cbranch_scc1 L_fin
  s_add_u32 s4, s0, s59
  s_addc_u32 s5, s1, 0
  s_mov_b32 s6, s36
  s_atomic_swap s6, s[4:5], 0
  s_waitcnt lgkmcnt(0)
L_fin:
L_end:
  s_endpgm
.section .rodata,"a"
.p2align 6
.amdhsa_kernel gated_mix__sliding_block__sliding_local_dilated__prompt_kernel
  .amdhsa_next_free_vgpr 256
  .amdhsa_next_free_sgpr 102
  .amdhsa_accum_offset 256
  .amdhsa_group_segment_fixed_size 0
  .amdhsa_kernarg_size 80
  .amdhsa_user_sgpr_count 2
  .amdhsa_user_sgpr_kernarg_segment_ptr 1
  .amdhsa_system_sgpr_workgroup_id_x 1
.end_amdhsa_kernel
```
